```python
import torch

def _softmax(x, axis=-1):
    return torch.softmax(x, dim=axis)
def _gelu(x):
    return torch.nn.functional.gelu(x, approximate="tanh")
def _silu(x):
    return torch.nn.functional.silu(x)
def _sigmoid(x):
    return torch.sigmoid(x)
def _layernorm(x, axis=-1, eps=1e-5):
    m = x.mean(dim=axis, keepdim=True)
    v = x.var(dim=axis, keepdim=True, unbiased=False)
    return (x - m) / torch.sqrt(v + eps)
def _scatter_add(tgt, idx, src, axis=0):
    return tgt.clone().index_add_(axis, idx, src)
def _segment_sum(src, seg, n):
    out = torch.zeros((n,) + src.shape[1:], dtype=src.dtype)
    return out.index_add_(0, seg, src)
def _pad(x, pw):
    flat = tuple(v for pair in reversed(pw) for v in pair)
    return torch.nn.functional.pad(x, flat)

kernel_name = 'concat_heads__ssm_conv_s4__linear_kernel_hedgehog__prompt'

def setup_inputs():

    _w = (lambda a: (lambda t: t.to(torch.bfloat16) if t.is_floating_point() else t)(torch.as_tensor(a)))
    def _A_setup():
        B, L, D, N = 1, 2048, 448, 256
        A_re = -(lambda _x: torch.exp(torch.as_tensor(_x)))((lambda *s: torch.randn(*s, dtype=torch.bfloat16) * 3.2)(D, N))
        A_im = torch.pi * (lambda *s: torch.randn(*s, dtype=torch.bfloat16) * 0.2)(D, N)
        B_re = (lambda *s: torch.randn(*s, dtype=torch.bfloat16) * 0.4)(D, N)
        B_im = (lambda *s: torch.randn(*s, dtype=torch.bfloat16) * 0.4)(D, N)
        C_re = (lambda *s: torch.randn(*s, dtype=torch.bfloat16) * 0.4)(D, N)
        C_im = (lambda *s: torch.randn(*s, dtype=torch.bfloat16) * 0.4)(D, N)
        log_dt = (lambda *s: torch.randn(*s, dtype=torch.bfloat16) * 0.2)(D) * 0.5 - 4.0
        Dskip = (lambda *s: torch.randn(*s, dtype=torch.bfloat16) * 0.4)(D)
        return {
            "u": _w((lambda *s: torch.randn(*s, dtype=torch.bfloat16) * 0.05)(B, L, D)),
            "A_re": _w(A_re),
            "A_im": _w(A_im),
            "B_re": _w(B_re),
            "B_im": _w(B_im),
            "C_re": _w(C_re),
            "C_im": _w(C_im),
            "log_dt": _w(log_dt),
            "Dskip": _w(Dskip),
        }
    _A_in = _A_setup()

    def _B_setup():
        B, S, D, H = 1, 2048, 448, 16
        Dh = D // H
        return {
            "x": _w((lambda *s: torch.randn(*s, dtype=torch.bfloat16) * 0.4)(B, S, D)),
            "wqkv": _w((lambda *s: torch.randn(*s, dtype=torch.bfloat16) * 0.4)(D, 3 * D)),
            "w_phi": _w((lambda *s: torch.randn(*s, dtype=torch.bfloat16) * 0.4)(H, Dh, Dh) * (Dh ** -0.5)),
            "wo": _w((lambda *s: torch.randn(*s, dtype=torch.bfloat16) * 0.05)(D, D)),
        }
    _B_in = _B_setup()

    return {
        "A_u": _A_in["u"],
        "A_A_re": _A_in["A_re"],
        "A_A_im": _A_in["A_im"],
        "A_B_re": _A_in["B_re"],
        "A_B_im": _A_in["B_im"],
        "A_C_re": _A_in["C_re"],
        "A_C_im": _A_in["C_im"],
        "A_log_dt": _A_in["log_dt"],
        "A_Dskip": _A_in["Dskip"],
        "B_x": _B_in["x"],
        "B_wqkv": _B_in["wqkv"],
        "B_w_phi": _B_in["w_phi"],
        "B_wo": _B_in["wo"],
    }

def reference(A_u, A_A_re, A_A_im, A_B_re, A_B_im, A_C_re, A_C_im, A_log_dt, A_Dskip, B_x, B_wqkv, B_w_phi, B_wo):
    def _A_ref(u, A_re, A_im, B_re, B_im, C_re, C_im, log_dt, Dskip):
        Bsz, L, D = u.shape
        dt = torch.exp(log_dt)[:, None]
        A = A_re + 1j * A_im
        Bc = B_re + 1j * B_im
        Cc = C_re + 1j * C_im
        logdA = dt * A
        dB = dt * Bc
        l = (lambda x, dt: x.to(dt))(torch.arange(L), A_re.dtype)
        P = torch.exp(logdA[:, :, None] * l[None, None, :])
        K = torch.einsum("dn,dnl,dn->dl", Cc, P, dB).real
        L2 = 2 * L
        Kp = _pad(K, ((0, 0), (0, L)))
        up = (lambda x, *d: x.permute(*d))(u, 0, 2, 1)
        up = _pad(up, ((0, 0), (0, 0), (0, L)))
        Kf = (lambda x, axes=(-2,-1): torch.fft.rfft2(x.float(), dim=axes))(Kp[:, None, :], axes=(-2, -1))
        Uf = (lambda x, axes=(-2,-1): torch.fft.rfft2(x.float(), dim=axes))(up[:, :, None, :], axes=(-2, -1))
        Yf = Uf * Kf[None, :, :, :]
        y = (lambda x, s, axes=(-2,-1): torch.fft.irfft2(x, s=s, dim=axes).to(torch.bfloat16))(Yf, (1, L2), axes=(-2, -1))[:, :, 0, :L]
        y = (lambda x, *d: x.permute(*d))(y, 0, 2, 1) + u * Dskip[None, None, :]
        return y

    def _B_ref(x, wqkv, w_phi, wo):
        B, S, D = x.shape
        H = 16; Dh = D // H
        qkv = (lambda x, *d: x.permute(*d))((x @ wqkv).reshape(B, S, 3, H, Dh), 2, 0, 3, 1, 4)
        q, k, v = qkv[0], qkv[1], qkv[2]
        pq = torch.einsum("bhsd,hdf->bhsf", q, w_phi)
        pk = torch.einsum("bhsd,hdf->bhsf", k, w_phi)
        phi_q = torch.concatenate([_softmax(pq, axis=-1), _softmax(-pq, axis=-1)], axis=-1)
        phi_k = torch.concatenate([_softmax(pk, axis=-1), _softmax(-pk, axis=-1)], axis=-1)
        kv = torch.einsum("bhsf,bhsd->bhfd", phi_k, v)
        z  = torch.einsum("bhsf->bhf", phi_k)
        num = torch.einsum("bhqf,bhfd->bhqd", phi_q, kv)
        den = torch.einsum("bhqf,bhf->bhq", phi_q, z)[..., None] + 1e-6
        o = num / den
        return (lambda x, *d: x.permute(*d))(o, 0, 2, 1, 3).reshape(B, S, D) @ wo

    a = _A_ref(A_u, A_A_re, A_A_im, A_B_re, A_B_im, A_C_re, A_C_im, A_log_dt, A_Dskip)
    b = _B_ref(B_x, B_wqkv, B_w_phi, B_wo)
    return torch.concatenate([a, b], axis=-1)
```

```asm
; @launch grid=(256,1,1) block=(768,1,1) lds=163840
.amdgcn_target "amdgcn-amd-amdhsa--gfx950"
.text
.globl concat_heads__ssm_conv_s4__linear_kernel_hedgehog__prompt_kernel
.p2align 8
.type concat_heads__ssm_conv_s4__linear_kernel_hedgehog__prompt_kernel,@function
concat_heads__ssm_conv_s4__linear_kernel_hedgehog__prompt_kernel:
  s_cmp_ge_u32 s2, 256
  s_cbranch_scc1 Lexit
  s_getpc_b64 s[6:7]
Lpc0:
  s_load_dwordx16 s[8:23], s[0:1], 0
  s_load_dwordx16 s[24:39], s[0:1], 64
  v_and_b32 v1, 63, v0
  v_lshrrev_b32 v2, 6, v0
  s_and_b32 s64, s2, 7
  v_readfirstlane_b32 s3, v2
  s_lshr_b32 s65, s2, 3
  s_lshl_b32 s68, s64, 2
  s_and_b32 s70, s65, 3
  s_add_u32 s68, s68, s70
  s_lshr_b32 s69, s65, 2
  s_lshl_b32 s40, s65, 10
  s_cmp_ge_u32 s40, Lcode_end-Lpc0-1024
  s_cbranch_scc1 Lnopf
  s_cmp_lg_u32 s3, 11
  s_cbranch_scc1 Lnopf
  v_lshlrev_b32 v3, 4, v1
  v_add_u32 v3, s40, v3
  global_load_dwordx4 v[124:127], v3, s[6:7]
Lnopf:
  s_cmp_lg_u32 s3, 11
  s_cbranch_scc1 Lnt_1
  s_waitcnt lgkmcnt(0)
  v_and_b32 v4, 1, v1
  v_mul_u32_u24 v4, 0x200000, v4
  v_lshlrev_b32 v5, 7, v1
  v_add_u32 v4, v4, v5
  s_mov_b64 exec, 3
  global_load_dword v120, v4, s[34:35]
  s_mov_b64 exec, 7
  v_mul_u32_u24 v4, 0x200000, v1
  global_load_dword v121, v4, s[38:39] offset:2048
  s_mov_b64 exec, -1
Lnt_1:
  s_cmp_ge_u32 s65, 16
  s_cbranch_scc1 Lrole_a
  s_lshr_b32 s66, s64, 1
  s_lshl_b32 s66, s66, 2
  s_and_b32 s70, s65, 3
  s_add_u32 s66, s66, s70
  s_and_b32 s67, s64, 1
  s_lshl_b32 s67, s67, 2
  s_add_u32 s67, s67, s69
  s_cmp_ge_u32 s3, 8
  s_cbranch_scc1 Lb_loader
  s_setprio 2
  s_mov_b32 s78, 0x3fb8aa3b
  s_mov_b32 s79, 0x3fb8aa3b
  s_mov_b32 s100, 0xbfb8aa3b
  s_mov_b32 s101, 0xbfb8aa3b
  s_and_b32 s60, s3, 3
  s_lshr_b32 s61, s3, 2
  s_lshl_b32 s62, s67, 1
  s_add_u32 s62, s62, s61
  s_mul_i32 s72, s61, 27648
  s_add_u32 s72, s72, 98304
  s_lshl_b32 s71, s60, 12
  v_and_b32 v10, 31, v1
  v_lshrrev_b32 v11, 5, v1
  v_lshrrev_b32 v12, 1, v10
  v_and_b32 v12, 7, v12
  v_xor_b32 v12, v12, v11
  v_lshlrev_b32 v12, 4, v12
  v_lshlrev_b32 v13, 7, v10
  v_add3_u32 v2, v13, v12, s71
  v_xor_b32 v3, 32, v2
  v_xor_b32 v14, 64, v2
  v_xor_b32 v15, 96, v2
  s_lshl_b32 s70, s60, 5
  v_add_u32 v13, s70, v10
  v_mul_u32_u24 v13, 72, v13
  v_lshlrev_b32 v12, 3, v11
  v_add3_u32 v5, v13, v12, s72
  v_lshrrev_b32 v10, 5, v1
  v_lshlrev_b32 v10, 3, v10
  v_lshrrev_b32 v11, 2, v1
  v_and_b32 v11, 3, v11
  v_add_u32 v10, v10, v11
  v_lshrrev_b32 v12, 4, v1
  v_and_b32 v12, 1, v12
  v_lshlrev_b32 v12, 5, v12
  v_and_b32 v13, 3, v1
  v_lshlrev_b32 v13, 3, v13
  v_add_u32 v12, v12, v13
  v_mul_u32_u24 v13, 72, v10
  v_add3_u32 v6, v13, v12, s72
  v_lshlrev_b32 v13, 8, v10
  v_add_u32 v13, v13, v12
  v_add_u32 v13, 49152, v13
  v_xor_b32 v4, s61, v11
  v_xor_b32 v127, 2, v4
  v_lshl_add_u32 v4, v4, 6, v13
  v_lshl_add_u32 v127, v127, 6, v13
  v_lshlrev_b32 v13, 7, v10
  v_add_u32 v13, v13, v12
  v_add_u32 v13, 49152, v13
  v_lshrrev_b32 v126, 1, v11
  v_xor_b32 v126, s61, v126
  v_lshl_add_u32 v126, v126, 6, v13
  v_lshrrev_b32 v10, 5, v1
  v_lshlrev_b32 v10, 2, v10
  v_add_u32 v10, v10, v11
  v_mul_u32_u24 v10, 56, v10
  s_mul_i32 s70, s61, 1568
  s_add_u32 s70, s70, 153600
  v_add3_u32 v7, v10, v12, s70
  v_add_u32 v8, 1344, v7
  v_mov_b32 v13, 157696
  v_cmp_lt_u32 vcc, 31, v1
  v_mov_b32 v9, 0xff800000
  s_nop 0
  v_cndmask_b32 v8, v8, v13, vcc
  v_lshlrev_b32 v10, 2, v1
  v_add_u32 v10, 157696, v10
  v_mov_b32 v11, 0
  s_mov_b32 exec_hi, 0
  ds_write_b32 v10, v11
  s_mov_b32 exec_hi, -1
  v_mov_b32 v16, 0
  v_mov_b32 v17, 0
  v_mov_b32 v18, 0
  v_mov_b32 v19, 0
  v_mov_b32 v20, 0
  v_mov_b32 v21, 0
  v_mov_b32 v22, 0
  v_mov_b32 v23, 0
  v_mov_b32 v24, 0
  v_mov_b32 v25, 0
  v_mov_b32 v26, 0
  v_mov_b32 v27, 0
  v_mov_b32 v28, 0
  v_mov_b32 v29, 0
  v_mov_b32 v30, 0
  v_mov_b32 v31, 0
  v_mov_b32 v32, 0
  v_mov_b32 v33, 0
  v_mov_b32 v34, 0
  v_mov_b32 v35, 0
  v_mov_b32 v36, 0
  v_mov_b32 v37, 0
  v_mov_b32 v38, 0
  v_mov_b32 v39, 0
  v_mov_b32 v40, 0
  v_mov_b32 v41, 0
  v_mov_b32 v42, 0
  v_mov_b32 v43, 0
  v_mov_b32 v44, 0
  v_mov_b32 v45, 0
  v_mov_b32 v46, 0
  v_mov_b32 v47, 0
  v_mov_b32 v48, 0
  v_mov_b32 v49, 0
  v_mov_b32 v50, 0
  v_mov_b32 v51, 0
  v_mov_b32 v52, 0
  v_mov_b32 v53, 0
  v_mov_b32 v54, 0
  v_mov_b32 v55, 0
  v_mov_b32 v56, 0
  v_mov_b32 v57, 0
  v_mov_b32 v58, 0
  v_mov_b32 v59, 0
  v_mov_b32 v60, 0
  v_mov_b32 v61, 0
  v_mov_b32 v62, 0
  v_mov_b32 v63, 0
  s_waitcnt lgkmcnt(0)
  s_mov_b32 s48, s38
  s_and_b32 s49, s39, 0xffff
  s_mov_b32 s50, 268435456
  s_mov_b32 s51, 0x20000
  s_mov_b32 s74, 16384
  s_mov_b32 s75, 0xffff8000
  s_mov_b32 s77, 0
  s_barrier
  ds_read_b128 v[64:67], v2
  ds_read_b64_tr_b16 v[68:69], v4 offset:0
  ds_read_b64_tr_b16 v[70:71], v4 offset:1024
  ds_read_b64_tr_b16 v[72:73], v127 offset:0
  ds_read_b64_tr_b16 v[74:75], v127 offset:1024
  s_mov_b32 s73, 0
Lmain_2:
  ds_read_b128 v[80:83], v3
  ds_read_b64_tr_b16 v[84:85], v4 offset:4096
  ds_read_b64_tr_b16 v[86:87], v4 offset:5120
  ds_read_b64_tr_b16 v[88:89], v127 offset:4096
  ds_read_b64_tr_b16 v[90:91], v127 offset:5120
  s_add_u32 s77, s77, 1
  s_cmp_eq_u32 s77, 3
  s_cselect_b32 s70, s75, s74
  s_cselect_b32 s77, 0, s77
  s_waitcnt lgkmcnt(5)
  v_mfma_f32_32x32x16_bf16 v[16:31], v[68:71], v[64:67], v[16:31]
  v_mfma_f32_32x32x16_bf16 v[32:47], v[72:75], v[64:67], v[32:47]
  ds_read_b128 v[64:67], v14
  ds_read_b64_tr_b16 v[68:69], v4 offset:8192
  ds_read_b64_tr_b16 v[70:71], v4 offset:9216
  ds_read_b64_tr_b16 v[72:73], v127 offset:8192
  ds_read_b64_tr_b16 v[74:75], v127 offset:9216
  s_waitcnt lgkmcnt(5)
  v_mfma_f32_32x32x16_bf16 v[16:31], v[84:87], v[80:83], v[16:31]
  v_mfma_f32_32x32x16_bf16 v[32:47], v[88:91], v[80:83], v[32:47]
  ds_read_b128 v[80:83], v15
  ds_read_b64_tr_b16 v[84:85], v4 offset:12288
  ds_read_b64_tr_b16 v[86:87], v4 offset:13312
  ds_read_b64_tr_b16 v[88:89], v127 offset:12288
  ds_read_b64_tr_b16 v[90:91], v127 offset:13312
  s_waitcnt lgkmcnt(5)
  v_mfma_f32_32x32x16_bf16 v[16:31], v[68:71], v[64:67], v[16:31]
  v_mfma_f32_32x32x16_bf16 v[32:47], v[72:75], v[64:67], v[32:47]
  v_add_u32 v2, s70, v2
  v_add_u32 v3, s70, v3
  v_add_u32 v14, s70, v14
  v_add_u32 v15, s70, v15
  v_add_u32 v4, s70, v4
  v_add_u32 v127, s70, v127
  v_add_u32 v126, s70, v126
  s_waitcnt lgkmcnt(0)
  s_barrier
  ds_read_b128 v[64:67], v2
  ds_read_b64_tr_b16 v[68:69], v4 offset:0
  ds_read_b64_tr_b16 v[70:71], v4 offset:1024
  ds_read_b64_tr_b16 v[72:73], v127 offset:0
  ds_read_b64_tr_b16 v[74:75], v127 offset:1024
  v_mfma_f32_32x32x16_bf16 v[16:31], v[84:87], v[80:83], v[16:31]
  v_mfma_f32_32x32x16_bf16 v[32:47], v[88:91], v[80:83], v[32:47]
  s_add_u32 s73, s73, 1
  s_cmp_lt_u32 s73, 7
  s_cbranch_scc1 Lmain_2
  ds_read_b64_tr_b16 v[96:97], v7
  ds_read_b64_tr_b16 v[98:99], v7 offset:448
  ds_read_b64_tr_b16 v[100:101], v7 offset:896
  ds_read_b64_tr_b16 v[102:103], v8
  s_mov_b32 vcc_lo, 0
  s_mov_b32 vcc_hi, -1
  s_nop 7
  s_waitcnt lgkmcnt(0)
  v_cvt_pk_bf16_f32 v80, v16, v17
  v_cvt_pk_bf16_f32 v81, v18, v19
  v_cvt_pk_bf16_f32 v82, v20, v21
  v_cvt_pk_bf16_f32 v83, v22, v23
  v_cvt_pk_bf16_f32 v84, v24, v25
  v_cvt_pk_bf16_f32 v85, v26, v27
  v_cvt_pk_bf16_f32 v86, v28, v29
  v_cvt_pk_bf16_f32 v87, v30, v31
  s_nop 1
  v_mfma_f32_32x32x16_bf16 v[64:79], v[96:99], v[80:83], 0
  v_mfma_f32_32x32x16_bf16 v[64:79], v[100:103], v[84:87], v[64:79]
  s_nop 11
  v_max3_f32 v88, v64, v65, v66
  v_max3_f32 v89, -v64, -v65, -v66
  v_max3_f32 v90, v76, v77, v78
  v_max3_f32 v91, -v76, -v77, -v78
  v_max3_f32 v88, v88, v67, v68
  v_max3_f32 v89, v89, -v67, -v68
  v_max3_f32 v88, v88, v69, v70
  v_max3_f32 v89, v89, -v69, -v70
  v_max3_f32 v88, v88, v71, v72
  v_max3_f32 v89, v89, -v71, -v72
  v_max3_f32 v88, v88, v73, v74
  v_max3_f32 v89, v89, -v73, -v74
  v_max_f32 v90, v90, v79
  v_max_f32_e64 v91, v91, -v79
  v_cndmask_b32 v90, v90, v9, vcc
  v_cndmask_b32 v91, v91, v9, vcc
  v_max3_f32 v88, v88, v75, v90
  v_max3_f32 v89, v89, -v75, v91
  s_nop 1
  v_permlane32_swap_b32 v88, v89
  s_nop 0
  v_max_f32 v92, v88, v89
  v_mov_b32 v93, v92
  s_nop 1
  v_permlane32_swap_b32 v92, v93
  s_nop 0
  v_mul_f32 v94, 0xbfb8aa3b, v92
  v_mul_f32 v122, 0xbfb8aa3b, v93
  v_cndmask_b32 v120, v94, v9, vcc
  v_cndmask_b32 v124, v122, v9, vcc
  v_pk_fma_f32 v[104:105], v[64:65], s[78:79], v[94:95] op_sel_hi:[1,1,0]
  v_pk_fma_f32 v[64:65], v[64:65], s[100:101], v[122:123] op_sel_hi:[1,1,0]
  v_pk_fma_f32 v[106:107], v[66:67], s[78:79], v[94:95] op_sel_hi:[1,1,0]
  v_pk_fma_f32 v[66:67], v[66:67], s[100:101], v[122:123] op_sel_hi:[1,1,0]
  v_pk_fma_f32 v[108:109], v[68:69], s[78:79], v[94:95] op_sel_hi:[1,1,0]
  v_pk_fma_f32 v[68:69], v[68:69], s[100:101], v[122:123] op_sel_hi:[1,1,0]
  v_pk_fma_f32 v[110:111], v[70:71], s[78:79], v[94:95] op_sel_hi:[1,1,0]
  v_pk_fma_f32 v[70:71], v[70:71], s[100:101], v[122:123] op_sel_hi:[1,1,0]
  v_pk_fma_f32 v[112:113], v[72:73], s[78:79], v[94:95] op_sel_hi:[1,1,0]
  v_pk_fma_f32 v[72:73], v[72:73], s[100:101], v[122:123] op_sel_hi:[1,1,0]
  v_pk_fma_f32 v[114:115], v[74:75], s[78:79], v[94:95] op_sel_hi:[1,1,0]
  v_pk_fma_f32 v[74:75], v[74:75], s[100:101], v[122:123] op_sel_hi:[1,1,0]
  v_pk_fma_f32 v[116:117], v[76:77], s[78:79], v[120:121] op_sel_hi:[1,1,0]
  v_pk_fma_f32 v[76:77], v[76:77], s[100:101], v[124:125] op_sel_hi:[1,1,0]
  v_pk_fma_f32 v[118:119], v[78:79], s[78:79], v[120:121] op_sel_hi:[1,1,0]
  v_pk_fma_f32 v[78:79], v[78:79], s[100:101], v[124:125] op_sel_hi:[1,1,0]
  v_exp_f32 v104, v104
  v_exp_f32 v64, v64
  v_exp_f32 v105, v105
  v_exp_f32 v65, v65
  v_exp_f32 v106, v106
  v_exp_f32 v66, v66
  v_exp_f32 v107, v107
  v_exp_f32 v67, v67
  v_exp_f32 v108, v108
  v_exp_f32 v68, v68
  v_exp_f32 v109, v109
  v_exp_f32 v69, v69
  v_exp_f32 v110, v110
  v_exp_f32 v70, v70
  v_exp_f32 v111, v111
  v_exp_f32 v71, v71
  v_exp_f32 v112, v112
  v_exp_f32 v72, v72
  v_exp_f32 v113, v113
  v_exp_f32 v73, v73
  v_exp_f32 v114, v114
  v_exp_f32 v74, v74
  v_exp_f32 v115, v115
  v_exp_f32 v75, v75
  v_exp_f32 v116, v116
  v_exp_f32 v76, v76
  v_exp_f32 v117, v117
  v_exp_f32 v77, v77
  v_exp_f32 v118, v118
  v_exp_f32 v78, v78
  v_exp_f32 v119, v119
  v_exp_f32 v79, v79
  v_pk_add_f32 v[90:91], v[104:105], v[106:107]
  v_pk_add_f32 v[92:93], v[64:65], v[66:67]
  v_pk_add_f32 v[90:91], v[90:91], v[108:109]
  v_pk_add_f32 v[92:93], v[92:93], v[68:69]
  v_pk_add_f32 v[90:91], v[90:91], v[110:111]
  v_pk_add_f32 v[92:93], v[92:93], v[70:71]
  v_pk_add_f32 v[90:91], v[90:91], v[112:113]
  v_pk_add_f32 v[92:93], v[92:93], v[72:73]
  v_pk_add_f32 v[90:91], v[90:91], v[114:115]
  v_pk_add_f32 v[92:93], v[92:93], v[74:75]
  v_pk_add_f32 v[90:91], v[90:91], v[116:117]
  v_pk_add_f32 v[92:93], v[92:93], v[76:77]
  v_pk_add_f32 v[90:91], v[90:91], v[118:119]
  v_pk_add_f32 v[92:93], v[92:93], v[78:79]
  v_add_f32 v88, v90, v91
  v_add_f32 v89, v92, v93
  s_nop 1
  v_permlane32_swap_b32 v88, v89
  s_nop 0
  v_add_f32 v90, v88, v89
  v_rcp_f32 v94, v90
  s_nop 0
  v_mov_b32 v122, v94
  s_nop 1
  v_permlane32_swap_b32 v94, v122
  s_nop 0
  v_pk_mul_f32 v[104:105], v[104:105], v[94:95] op_sel_hi:[1,0]
  v_pk_mul_f32 v[64:65], v[64:65], v[122:123] op_sel_hi:[1,0]
  v_pk_mul_f32 v[106:107], v[106:107], v[94:95] op_sel_hi:[1,0]
  v_pk_mul_f32 v[66:67], v[66:67], v[122:123] op_sel_hi:[1,0]
  v_pk_mul_f32 v[108:109], v[108:109], v[94:95] op_sel_hi:[1,0]
  v_pk_mul_f32 v[68:69], v[68:69], v[122:123] op_sel_hi:[1,0]
  v_pk_mul_f32 v[110:111], v[110:111], v[94:95] op_sel_hi:[1,0]
  v_pk_mul_f32 v[70:71], v[70:71], v[122:123] op_sel_hi:[1,0]
  v_pk_mul_f32 v[112:113], v[112:113], v[94:95] op_sel_hi:[1,0]
  v_pk_mul_f32 v[72:73], v[72:73], v[122:123] op_sel_hi:[1,0]
  v_pk_mul_f32 v[114:115], v[114:115], v[94:95] op_sel_hi:[1,0]
  v_pk_mul_f32 v[74:75], v[74:75], v[122:123] op_sel_hi:[1,0]
  v_pk_mul_f32 v[116:117], v[116:117], v[94:95] op_sel_hi:[1,0]
  v_pk_mul_f32 v[76:77], v[76:77], v[122:123] op_sel_hi:[1,0]
  v_pk_mul_f32 v[118:119], v[118:119], v[94:95] op_sel_hi:[1,0]
  v_pk_mul_f32 v[78:79], v[78:79], v[122:123] op_sel_hi:[1,0]
  v_cvt_pk_bf16_f32 v16, v104, v105
  v_cvt_pk_bf16_f32 v24, v64, v65
  v_cvt_pk_bf16_f32 v17, v106, v107
  v_cvt_pk_bf16_f32 v25, v66, v67
  v_cvt_pk_bf16_f32 v18, v108, v109
  v_cvt_pk_bf16_f32 v26, v68, v69
  v_cvt_pk_bf16_f32 v19, v110, v111
  v_cvt_pk_bf16_f32 v27, v70, v71
  v_cvt_pk_bf16_f32 v20, v112, v113
  v_cvt_pk_bf16_f32 v28, v72, v73
  v_cvt_pk_bf16_f32 v21, v114, v115
  v_cvt_pk_bf16_f32 v29, v74, v75
  v_cvt_pk_bf16_f32 v22, v116, v117
  v_cvt_pk_bf16_f32 v30, v76, v77
  v_cvt_pk_bf16_f32 v23, v118, v119
  v_cvt_pk_bf16_f32 v31, v78, v79
  v_mov_b32 v88, 1.0
  v_mov_b32 v89, 0
  v_cndmask_b32 v44, v44, v88, vcc
  v_cndmask_b32 v45, v45, v89, vcc
  v_cndmask_b32 v46, v46, v89, vcc
  v_cndmask_b32 v47, v47, v89, vcc
  v_cvt_pk_bf16_f32 v32, v32, v33
  v_cvt_pk_bf16_f32 v33, v34, v35
  v_cvt_pk_bf16_f32 v34, v36, v37
  v_cvt_pk_bf16_f32 v35, v38, v39
  v_cvt_pk_bf16_f32 v36, v40, v41
  v_cvt_pk_bf16_f32 v37, v42, v43
  v_cvt_pk_bf16_f32 v38, v44, v45
  v_cvt_pk_bf16_f32 v39, v46, v47
  ds_write_b64 v5, v[16:17] offset:0
  ds_write_b64 v5, v[24:25] offset:9216
  ds_write_b64 v5, v[32:33] offset:18432
  ds_write_b64 v5, v[18:19] offset:16
  ds_write_b64 v5, v[26:27] offset:9232
  ds_write_b64 v5, v[34:35] offset:18448
  ds_write_b64 v5, v[20:21] offset:32
  ds_write_b64 v5, v[28:29] offset:9248
  ds_write_b64 v5, v[36:37] offset:18464
  ds_write_b64 v5, v[22:23] offset:48
  ds_write_b64 v5, v[30:31] offset:9264
  ds_write_b64 v5, v[38:39] offset:18480
  s_waitcnt lgkmcnt(0)
  s_barrier
  s_cmp_ge_u32 s60, 2
  s_cbranch_scc1 Lnokv_3
  s_mul_i32 s70, s60, 9216
  v_add_u32 v10, s70, v6
  ds_read_b64_tr_b16 v[64:65], v10 offset:0
  ds_read_b64_tr_b16 v[66:67], v10 offset:288
  ds_read_b64_tr_b16 v[68:69], v6 offset:18432
  ds_read_b64_tr_b16 v[70:71], v6 offset:18720
  ds_read_b64_tr_b16 v[72:73], v10 offset:1152
  ds_read_b64_tr_b16 v[74:75], v10 offset:1440
  ds_read_b64_tr_b16 v[76:77], v6 offset:19584
  ds_read_b64_tr_b16 v[78:79], v6 offset:19872
  ds_read_b64_tr_b16 v[80:81], v10 offset:2304
  ds_read_b64_tr_b16 v[82:83], v10 offset:2592
  ds_read_b64_tr_b16 v[84:85], v6 offset:20736
  ds_read_b64_tr_b16 v[86:87], v6 offset:21024
  ds_read_b64_tr_b16 v[88:89], v10 offset:3456
  ds_read_b64_tr_b16 v[90:91], v10 offset:3744
  ds_read_b64_tr_b16 v[92:93], v6 offset:21888
  ds_read_b64_tr_b16 v[94:95], v6 offset:22176
  s_waitcnt lgkmcnt(12)
  v_mfma_f32_32x32x16_bf16 v[104:119], v[64:67], v[68:71], 0
  ds_read_b64_tr_b16 v[64:65], v10 offset:4608
  ds_read_b64_tr_b16 v[66:67], v10 offset:4896
  ds_read_b64_tr_b16 v[68:69], v6 offset:23040
  ds_read_b64_tr_b16 v[70:71], v6 offset:23328
  s_waitcnt lgkmcnt(12)
  v_mfma_f32_32x32x16_bf16 v[104:119], v[72:75], v[76:79], v[104:119]
  ds_read_b64_tr_b16 v[72:73], v10 offset:5760
  ds_read_b64_tr_b16 v[74:75], v10 offset:6048
  ds_read_b64_tr_b16 v[76:77], v6 offset:24192
  ds_read_b64_tr_b16 v[78:79], v6 offset:24480
  s_waitcnt lgkmcnt(12)
  v_mfma_f32_32x32x16_bf16 v[104:119], v[80:83], v[84:87], v[104:119]
  ds_read_b64_tr_b16 v[80:81], v10 offset:6912
  ds_read_b64_tr_b16 v[82:83], v10 offset:7200
  ds_read_b64_tr_b16 v[84:85], v6 offset:25344
  ds_read_b64_tr_b16 v[86:87], v6 offset:25632
  s_waitcnt lgkmcnt(12)
  v_mfma_f32_32x32x16_bf16 v[104:119], v[88:91], v[92:95], v[104:119]
  ds_read_b64_tr_b16 v[88:89], v10 offset:8064
  ds_read_b64_tr_b16 v[90:91], v10 offset:8352
  ds_read_b64_tr_b16 v[92:93], v6 offset:26496
  ds_read_b64_tr_b16 v[94:95], v6 offset:26784
  s_waitcnt lgkmcnt(12)
  v_mfma_f32_32x32x16_bf16 v[104:119], v[64:67], v[68:71], v[104:119]
  s_waitcnt lgkmcnt(8)
  v_mfma_f32_32x32x16_bf16 v[104:119], v[72:75], v[76:79], v[104:119]
  s_waitcnt lgkmcnt(4)
  v_mfma_f32_32x32x16_bf16 v[104:119], v[80:83], v[84:87], v[104:119]
  s_waitcnt lgkmcnt(0)
  v_mfma_f32_32x32x16_bf16 v[104:119], v[88:91], v[92:95], v[104:119]
  s_lshl_b32 s70, s62, 4
  s_add_u32 s70, s70, s66
  s_lshl_b32 s70, s70, 12
  s_lshl_b32 s71, s60, 11
  s_add_u32 s70, s70, s71
  s_add_u32 s70, s70, 1048576
  v_lshlrev_b32 v11, 4, v1
  s_nop 4
  v_cvt_pk_bf16_f32 v64, v104, v105
  v_cvt_pk_bf16_f32 v65, v106, v107
  v_cvt_pk_bf16_f32 v66, v108, v109
  v_cvt_pk_bf16_f32 v67, v110, v111
  v_cvt_pk_bf16_f32 v68, v112, v113
  v_cvt_pk_bf16_f32 v69, v114, v115
  v_cvt_pk_bf16_f32 v70, v116, v117
  v_cvt_pk_bf16_f32 v71, v118, v119
  buffer_store_dwordx4 v[64:67], v11, s[48:51], s70 offen sc1
  buffer_store_dwordx4 v[68:71], v11, s[48:51], s70 offen offset:1024 sc1
  s_nop 1
Lnokv_3:
  s_waitcnt lgkmcnt(0)
  ds_read_b128 v[64:67], v2
  ds_read_b64_tr_b16 v[68:69], v126 offset:0
  ds_read_b64_tr_b16 v[70:71], v126 offset:512
  s_mov_b32 s73, 0
Lmain_4:
  ds_read_b128 v[80:83], v3
  ds_read_b64_tr_b16 v[84:85], v126 offset:2048
  ds_read_b64_tr_b16 v[86:87], v126 offset:2560
  s_add_u32 s77, s77, 1
  s_cmp_eq_u32 s77, 3
  s_cselect_b32 s70, s75, s74
  s_cselect_b32 s77, 0, s77
  s_waitcnt lgkmcnt(3)
  v_mfma_f32_32x32x16_bf16 v[48:63], v[68:71], v[64:67], v[48:63]
  ds_read_b128 v[64:67], v14
  ds_read_b64_tr_b16 v[68:69], v126 offset:4096
  ds_read_b64_tr_b16 v[70:71], v126 offset:4608
  s_waitcnt lgkmcnt(3)
  v_mfma_f32_32x32x16_bf16 v[48:63], v[84:87], v[80:83], v[48:63]
  ds_read_b128 v[80:83], v15
  ds_read_b64_tr_b16 v[84:85], v126 offset:6144
  ds_read_b64_tr_b16 v[86:87], v126 offset:6656
  s_waitcnt lgkmcnt(3)
  v_mfma_f32_32x32x16_bf16 v[48:63], v[68:71], v[64:67], v[48:63]
  v_add_u32 v2, s70, v2
  v_add_u32 v3, s70, v3
  v_add_u32 v14, s70, v14
  v_add_u32 v15, s70, v15
  v_add_u32 v4, s70, v4
  v_add_u32 v127, s70, v127
  v_add_u32 v126, s70, v126
  s_waitcnt lgkmcnt(0)
  s_barrier
  ds_read_b128 v[64:67], v2
  ds_read_b64_tr_b16 v[68:69], v126 offset:0
  ds_read_b64_tr_b16 v[70:71], v126 offset:512
  v_mfma_f32_32x32x16_bf16 v[48:63], v[84:87], v[80:83], v[48:63]
  s_add_u32 s73, s73, 1
  s_cmp_lt_u32 s73, 7
  s_cbranch_scc1 Lmain_4
  s_mov_b32 vcc_lo, 0
  s_mov_b32 vcc_hi, -1
  s_nop 7
  s_waitcnt lgkmcnt(0)
  v_cvt_pk_bf16_f32 v80, v48, v49
  v_cvt_pk_bf16_f32 v81, v50, v51
  v_cvt_pk_bf16_f32 v82, v52, v53
  v_cvt_pk_bf16_f32 v83, v54, v55
  v_cvt_pk_bf16_f32 v84, v56, v57
  v_cvt_pk_bf16_f32 v85, v58, v59
  v_cvt_pk_bf16_f32 v86, v60, v61
  v_cvt_pk_bf16_f32 v87, v62, v63
  s_nop 1
  v_mfma_f32_32x32x16_bf16 v[64:79], v[96:99], v[80:83], 0
  v_mfma_f32_32x32x16_bf16 v[64:79], v[100:103], v[84:87], v[64:79]
  s_nop 11
  v_max3_f32 v88, v64, v65, v66
  v_max3_f32 v89, -v64, -v65, -v66
  v_max3_f32 v90, v76, v77, v78
  v_max3_f32 v91, -v76, -v77, -v78
  v_max3_f32 v88, v88, v67, v68
  v_max3_f32 v89, v89, -v67, -v68
  v_max3_f32 v88, v88, v69, v70
  v_max3_f32 v89, v89, -v69, -v70
  v_max3_f32 v88, v88, v71, v72
  v_max3_f32 v89, v89, -v71, -v72
  v_max3_f32 v88, v88, v73, v74
  v_max3_f32 v89, v89, -v73, -v74
  v_max_f32 v90, v90, v79
  v_max_f32_e64 v91, v91, -v79
  v_cndmask_b32 v90, v90, v9, vcc
  v_cndmask_b32 v91, v91, v9, vcc
  v_max3_f32 v88, v88, v75, v90
  v_max3_f32 v89, v89, -v75, v91
  s_nop 1
  v_permlane32_swap_b32 v88, v89
  s_nop 0
  v_max_f32 v92, v88, v89
  v_mov_b32 v93, v92
  s_nop 1
  v_permlane32_swap_b32 v92, v93
  s_nop 0
  v_mul_f32 v94, 0xbfb8aa3b, v92
  v_mul_f32 v122, 0xbfb8aa3b, v93
  v_cndmask_b32 v120, v94, v9, vcc
  v_cndmask_b32 v124, v122, v9, vcc
  v_pk_fma_f32 v[104:105], v[64:65], s[78:79], v[94:95] op_sel_hi:[1,1,0]
  v_pk_fma_f32 v[64:65], v[64:65], s[100:101], v[122:123] op_sel_hi:[1,1,0]
  v_pk_fma_f32 v[106:107], v[66:67], s[78:79], v[94:95] op_sel_hi:[1,1,0]
  v_pk_fma_f32 v[66:67], v[66:67], s[100:101], v[122:123] op_sel_hi:[1,1,0]
  v_pk_fma_f32 v[108:109], v[68:69], s[78:79], v[94:95] op_sel_hi:[1,1,0]
  v_pk_fma_f32 v[68:69], v[68:69], s[100:101], v[122:123] op_sel_hi:[1,1,0]
  v_pk_fma_f32 v[110:111], v[70:71], s[78:79], v[94:95] op_sel_hi:[1,1,0]
  v_pk_fma_f32 v[70:71], v[70:71], s[100:101], v[122:123] op_sel_hi:[1,1,0]
  v_pk_fma_f32 v[112:113], v[72:73], s[78:79], v[94:95] op_sel_hi:[1,1,0]
  v_pk_fma_f32 v[72:73], v[72:73], s[100:101], v[122:123] op_sel_hi:[1,1,0]
  v_pk_fma_f32 v[114:115], v[74:75], s[78:79], v[94:95] op_sel_hi:[1,1,0]
  v_pk_fma_f32 v[74:75], v[74:75], s[100:101], v[122:123] op_sel_hi:[1,1,0]
  v_pk_fma_f32 v[116:117], v[76:77], s[78:79], v[120:121] op_sel_hi:[1,1,0]
  v_pk_fma_f32 v[76:77], v[76:77], s[100:101], v[124:125] op_sel_hi:[1,1,0]
  v_pk_fma_f32 v[118:119], v[78:79], s[78:79], v[120:121] op_sel_hi:[1,1,0]
  v_pk_fma_f32 v[78:79], v[78:79], s[100:101], v[124:125] op_sel_hi:[1,1,0]
  v_exp_f32 v104, v104
  v_exp_f32 v64, v64
  v_exp_f32 v105, v105
  v_exp_f32 v65, v65
  v_exp_f32 v106, v106
  v_exp_f32 v66, v66
  v_exp_f32 v107, v107
  v_exp_f32 v67, v67
  v_exp_f32 v108, v108
  v_exp_f32 v68, v68
  v_exp_f32 v109, v109
  v_exp_f32 v69, v69
  v_exp_f32 v110, v110
  v_exp_f32 v70, v70
  v_exp_f32 v111, v111
  v_exp_f32 v71, v71
  v_exp_f32 v112, v112
  v_exp_f32 v72, v72
  v_exp_f32 v113, v113
  v_exp_f32 v73, v73
  v_exp_f32 v114, v114
  v_exp_f32 v74, v74
  v_exp_f32 v115, v115
  v_exp_f32 v75, v75
  v_exp_f32 v116, v116
  v_exp_f32 v76, v76
  v_exp_f32 v117, v117
  v_exp_f32 v77, v77
  v_exp_f32 v118, v118
  v_exp_f32 v78, v78
  v_exp_f32 v119, v119
  v_exp_f32 v79, v79
  v_pk_add_f32 v[90:91], v[104:105], v[106:107]
  v_pk_add_f32 v[92:93], v[64:65], v[66:67]
  v_pk_add_f32 v[90:91], v[90:91], v[108:109]
  v_pk_add_f32 v[92:93], v[92:93], v[68:69]
  v_pk_add_f32 v[90:91], v[90:91], v[110:111]
  v_pk_add_f32 v[92:93], v[92:93], v[70:71]
  v_pk_add_f32 v[90:91], v[90:91], v[112:113]
  v_pk_add_f32 v[92:93], v[92:93], v[72:73]
  v_pk_add_f32 v[90:91], v[90:91], v[114:115]
  v_pk_add_f32 v[92:93], v[92:93], v[74:75]
  v_pk_add_f32 v[90:91], v[90:91], v[116:117]
  v_pk_add_f32 v[92:93], v[92:93], v[76:77]
  v_pk_add_f32 v[90:91], v[90:91], v[118:119]
  v_pk_add_f32 v[92:93], v[92:93], v[78:79]
  v_add_f32 v88, v90, v91
  v_add_f32 v89, v92, v93
  s_nop 1
  v_permlane32_swap_b32 v88, v89
  s_nop 0
  v_add_f32 v90, v88, v89
  v_rcp_f32 v94, v90
  s_nop 0
  v_mov_b32 v122, v94
  s_nop 1
  v_permlane32_swap_b32 v94, v122
  s_nop 0
  v_pk_mul_f32 v[104:105], v[104:105], v[94:95] op_sel_hi:[1,0]
  v_pk_mul_f32 v[64:65], v[64:65], v[122:123] op_sel_hi:[1,0]
  v_pk_mul_f32 v[106:107], v[106:107], v[94:95] op_sel_hi:[1,0]
  v_pk_mul_f32 v[66:67], v[66:67], v[122:123] op_sel_hi:[1,0]
  v_pk_mul_f32 v[108:109], v[108:109], v[94:95] op_sel_hi:[1,0]
  v_pk_mul_f32 v[68:69], v[68:69], v[122:123] op_sel_hi:[1,0]
  v_pk_mul_f32 v[110:111], v[110:111], v[94:95] op_sel_hi:[1,0]
  v_pk_mul_f32 v[70:71], v[70:71], v[122:123] op_sel_hi:[1,0]
  v_pk_mul_f32 v[112:113], v[112:113], v[94:95] op_sel_hi:[1,0]
  v_pk_mul_f32 v[72:73], v[72:73], v[122:123] op_sel_hi:[1,0]
  v_pk_mul_f32 v[114:115], v[114:115], v[94:95] op_sel_hi:[1,0]
  v_pk_mul_f32 v[74:75], v[74:75], v[122:123] op_sel_hi:[1,0]
  v_pk_mul_f32 v[116:117], v[116:117], v[94:95] op_sel_hi:[1,0]
  v_pk_mul_f32 v[76:77], v[76:77], v[122:123] op_sel_hi:[1,0]
  v_pk_mul_f32 v[118:119], v[118:119], v[94:95] op_sel_hi:[1,0]
  v_pk_mul_f32 v[78:79], v[78:79], v[122:123] op_sel_hi:[1,0]
  v_cvt_pk_bf16_f32 v48, v104, v105
  v_cvt_pk_bf16_f32 v56, v64, v65
  v_cvt_pk_bf16_f32 v49, v106, v107
  v_cvt_pk_bf16_f32 v57, v66, v67
  v_cvt_pk_bf16_f32 v50, v108, v109
  v_cvt_pk_bf16_f32 v58, v68, v69
  v_cvt_pk_bf16_f32 v51, v110, v111
  v_cvt_pk_bf16_f32 v59, v70, v71
  v_cvt_pk_bf16_f32 v52, v112, v113
  v_cvt_pk_bf16_f32 v60, v72, v73
  v_cvt_pk_bf16_f32 v53, v114, v115
  v_cvt_pk_bf16_f32 v61, v74, v75
  v_cvt_pk_bf16_f32 v54, v116, v117
  v_cvt_pk_bf16_f32 v62, v76, v77
  v_cvt_pk_bf16_f32 v55, v118, v119
  v_cvt_pk_bf16_f32 v63, v78, v79
  s_lshl_b32 s72, s67, 13
  s_lshl_b32 s71, s61, 12
  s_add_u32 s72, s72, s71
  s_add_u32 s72, s72, 524288
  v_lshlrev_b32 v11, 4, v1
  s_mov_b32 s73, 0
  s_cmp_lg_u32 s60, 0
  s_cbranch_scc1 Lnrp_5
  v_lshlrev_b32 v10, 9, v1
  s_mov_b64 exec, 0xff
  s_mov_b32 s6, 0
Lsp_6:
  buffer_load_dword v12, v10, s[48:51], s72 offen sc1
  s_add_u32 s6, s6, 1
  s_waitcnt vmcnt(0)
  v_cmp_eq_u32 vcc, -1, v12
  s_cmp_gt_u32 s6, 100000
  s_cbranch_scc1 Lsdone_7
  s_cbranch_vccz Lsdone_7
  s_mov_b64 exec, vcc
  s_sleep 2
  s_branch Lsp_6
Lsdone_7:
  s_mov_b64 exec, -1
Lnrp_5:
  s_barrier
Lh1_8:
  buffer_load_dwordx4 v[64:67], v11, s[48:51], s72 offen offset:0 sc1
  buffer_load_dwordx4 v[68:71], v11, s[48:51], s72 offen offset:1024 sc1
  buffer_load_dwordx4 v[72:75], v11, s[48:51], s72 offen offset:2048 sc1
  buffer_load_dwordx4 v[76:79], v11, s[48:51], s72 offen offset:3072 sc1
  s_waitcnt vmcnt(0)
  v_max3_u32 v12, v64, v65, v66
  v_max3_u32 v12, v12, v67, v68
  v_max3_u32 v12, v12, v69, v70
  v_max3_u32 v12, v12, v71, v72
  v_max3_u32 v12, v12, v73, v74
  v_max3_u32 v12, v12, v75, v76
  v_max3_u32 v12, v12, v77, v78
  v_max_u32 v12, v12, v79
  s_add_u32 s73, s73, 1
  v_cmp_eq_u32 vcc, -1, v12
  s_cmp_gt_u32 s73, 25000
  s_cbranch_scc1 Lh1d_9
  s_cbranch_vccz Lh1d_9
  s_mov_b64 exec, vcc
  s_sleep 2
  s_branch Lh1_8
Lh1d_9:
  s_mov_b64 exec, -1
  v_and_b32 v10, 31, v1
  v_lshrrev_b32 v12, 4, v10
  v_lshlrev_b32 v12, 14, v12
  v_and_b32 v10, 15, v10
  v_lshlrev_b32 v10, 4, v10
  v_lshrrev_b32 v13, 5, v1
  v_lshlrev_b32 v13, 9, v13
  v_add3_u32 v10, v10, v12, v13
  s_lshl_b32 s70, s66, 3
  s_lshl_b32 s71, s60, 1
  s_add_u32 s70, s70, s71
  s_lshl_b32 s70, s70, 4
  s_add_u32 s70, s70, s62
  s_lshl_b32 s70, s70, 10
  s_add_u32 s70, s70, 2097152
  v_mfma_f32_32x32x16_bf16 v[80:95], v[64:67], v[48:51], 0
  v_mfma_f32_32x32x16_bf16 v[80:95], v[68:71], v[52:55], v[80:95]
  v_mfma_f32_32x32x16_bf16 v[80:95], v[72:75], v[56:59], v[80:95]
  v_mfma_f32_32x32x16_bf16 v[80:95], v[76:79], v[60:63], v[80:95]
  s_nop 11
  v_mov_b32 v96, v92
  v_mov_b32 v98, v92
  s_nop 1
  v_permlane32_swap_b32 v96, v98
  s_nop 0
  v_add_f32 v98, 0x358637bd, v98
  v_rcp_f32 v98, v98
  s_nop 0
  v_pk_mul_f32 v[80:81], v[80:81], v[98:99] op_sel_hi:[1,0]
  v_pk_mul_f32 v[82:83], v[82:83], v[98:99] op_sel_hi:[1,0]
  v_pk_mul_f32 v[84:85], v[84:85], v[98:99] op_sel_hi:[1,0]
  v_pk_mul_f32 v[86:87], v[86:87], v[98:99] op_sel_hi:[1,0]
  v_pk_mul_f32 v[88:89], v[88:89], v[98:99] op_sel_hi:[1,0]
  v_pk_mul_f32 v[90:91], v[90:91], v[98:99] op_sel_hi:[1,0]
  v_pk_mul_f32 v[92:93], v[92:93], v[98:99] op_sel_hi:[1,0]
  v_pk_mul_f32 v[94:95], v[94:95], v[98:99] op_sel_hi:[1,0]
  v_cvt_pk_bf16_f32 v100, v80, v81
  v_cvt_pk_bf16_f32 v101, v82, v83
  v_cvt_pk_bf16_f32 v102, v84, v85
  v_cvt_pk_bf16_f32 v103, v86, v87
  v_cvt_pk_bf16_f32 v104, v88, v89
  v_cvt_pk_bf16_f32 v105, v90, v91
  v_cvt_pk_bf16_f32 v106, v92, v93
  v_cvt_pk_bf16_f32 v107, v94, v95
  s_mov_b32 exec_lo, 0
  v_mov_b32 v106, 0
  v_mov_b32 v107, 0
  s_mov_b32 exec_lo, -1
  buffer_store_dwordx4 v[100:103], v10, s[48:51], s70 offen sc1
  buffer_store_dwordx4 v[104:107], v10, s[48:51], s70 offen offset:256 sc1
  s_mov_b32 s63, 0
  s_cmp_lt_u32 s3, 4
  s_cbranch_scc1 Lfinal
  s_barrier
  s_endpgm
Lb_loader:
  s_cmp_eq_u32 s3, 11
  s_cbranch_scc1 Lb_w11
  s_and_b32 s70, s65, 3
  s_lshr_b32 s71, s65, 2
  s_mul_i32 s71, s71, 7
  s_lshr_b32 s71, s71, 2
  s_mul_i32 s70, s70, 7
  s_lshr_b32 s70, s70, 2
  s_lshr_b32 s70, s70, 0
  s_add_u32 s74, s70, s71
  s_cmp_ge_u32 s74, 7
  s_cselect_b32 s70, 7, 0
  s_sub_u32 s74, s74, s70
  s_cmp_ge_u32 s3, 9
  s_cbranch_scc1 Lb_ldw
  v_lshrrev_b32 v10, 3, v1
  v_lshrrev_b32 v11, 4, v1
  v_and_b32 v12, 7, v1
  v_xor_b32 v13, v11, v12
  v_lshlrev_b32 v13, 4, v13
  s_lshl_b32 s70, s66, 7
  v_add_u32 v10, s70, v10
  v_mul_u32_u24 v10, 896, v10
  v_add_u32 v2, v10, v13
  v_xor_b32 v13, 64, v13
  v_add_u32 v19, v10, v13
  s_lshl_b32 s75, s74, 7
  s_mov_b32 s77, 0
  s_mov_b32 s73, 0
  s_waitcnt lgkmcnt(0)
  s_mov_b32 s40, s26
  s_and_b32 s41, s27, 0xffff
  s_mov_b32 s42, 1835008
  s_mov_b32 s43, 0x20000
  s_mov_b32 s48, s38
  s_and_b32 s49, s39, 0xffff
  s_mov_b32 s50, 268435456
  s_mov_b32 s51, 0x20000
  s_mov_b32 s52, s32
  s_and_b32 s53, s33, 0xffff
  s_mov_b32 s54, 401408
  s_mov_b32 s55, 0x20000
Lldx_10:
  s_cmp_lt_u32 s73, 2
  s_cbranch_scc1 Lldxn_11
  s_waitcnt vmcnt(16)
  s_barrier
Lldxn_11:
  s_mov_b32 m0, s77
  s_mov_b32 s70, s75
  buffer_load_dwordx4 v2, s[40:43], s70 offen lds
  s_add_u32 m0, m0, 1024
  s_add_u32 s70, s70, 7168
  buffer_load_dwordx4 v19, s[40:43], s70 offen lds
  s_add_u32 m0, m0, 1024
  s_add_u32 s70, s70, 7168
  buffer_load_dwordx4 v2, s[40:43], s70 offen lds
  s_add_u32 m0, m0, 1024
  s_add_u32 s70, s70, 7168
  buffer_load_dwordx4 v19, s[40:43], s70 offen lds
  s_add_u32 m0, m0, 1024
  s_add_u32 s70, s70, 7168
  buffer_load_dwordx4 v2, s[40:43], s70 offen lds
  s_add_u32 m0, m0, 1024
  s_add_u32 s70, s70, 7168
  buffer_load_dwordx4 v19, s[40:43], s70 offen lds
  s_add_u32 m0, m0, 1024
  s_add_u32 s70, s70, 7168
  buffer_load_dwordx4 v2, s[40:43], s70 offen lds
  s_add_u32 m0, m0, 1024
  s_add_u32 s70, s70, 7168
  buffer_load_dwordx4 v19, s[40:43], s70 offen lds
  s_add_u32 m0, m0, 1024
  s_add_u32 s70, s70, 7168
  buffer_load_dwordx4 v2, s[40:43], s70 offen lds
  s_add_u32 m0, m0, 1024
  s_add_u32 s70, s70, 7168
  buffer_load_dwordx4 v19, s[40:43], s70 offen lds
  s_add_u32 m0, m0, 1024
  s_add_u32 s70, s70, 7168
  buffer_load_dwordx4 v2, s[40:43], s70 offen lds
  s_add_u32 m0, m0, 1024
  s_add_u32 s70, s70, 7168
  buffer_load_dwordx4 v19, s[40:43], s70 offen lds
  s_add_u32 m0, m0, 1024
  s_add_u32 s70, s70, 7168
  buffer_load_dwordx4 v2, s[40:43], s70 offen lds
  s_add_u32 m0, m0, 1024
  s_add_u32 s70, s70, 7168
  buffer_load_dwordx4 v19, s[40:43], s70 offen lds
  s_add_u32 m0, m0, 1024
  s_add_u32 s70, s70, 7168
  buffer_load_dwordx4 v2, s[40:43], s70 offen lds
  s_add_u32 m0, m0, 1024
  s_add_u32 s70, s70, 7168
  buffer_load_dwordx4 v19, s[40:43], s70 offen lds
  s_add_u32 s75, s75, 128
  s_cmp_eq_u32 s75, 896
  s_cselect_b32 s75, 0, s75
  s_add_u32 s77, s77, 16384
  s_cmp_eq_u32 s77, 49152
  s_cselect_b32 s77, 0, s77
  s_cmp_lg_u32 s73, 9
  s_cbranch_scc1 Lldxc_12
  s_barrier
Lldxc_12:
  s_add_u32 s73, s73, 1
  s_cmp_lt_u32 s73, 14
  s_cbranch_scc1 Lldx_10
  s_waitcnt vmcnt(16)
  s_barrier
  s_waitcnt vmcnt(0)
  s_barrier
  v_lshrrev_b32 v10, 3, v1
  v_and_b32 v11, 7, v1
  v_lshrrev_b32 v12, 1, v11
  v_and_b32 v11, 1, v11
  v_lshlrev_b32 v11, 4, v11
  v_lshrrev_b32 v13, 1, v10
  v_and_b32 v13, 1, v13
  v_xor_b32 v12, v12, v13
  v_mul_u32_u24 v10, 896, v10
  s_lshl_b32 s70, s69, 7
  v_add3_u32 v10, v10, v11, s70
  v_lshlrev_b32 v13, 5, v12
  v_add_u32 v16, v10, v13
  v_xor_b32 v12, 2, v12
  v_lshlrev_b32 v13, 5, v12
  v_add_u32 v17, v10, v13
  s_mov_b32 s63, 0
  s_barrier
  v_lshlrev_b32 v24, 3, v1
  v_add_u32 v24, s63, v24
  v_add_u32 v24, 57344, v24
  v_mov_b32 v26, 0
  v_mov_b32 v27, 0
  ds_write_b64 v24, v[26:27]
  s_mov_b32 s73, 0
  s_mov_b32 s70, 0
  s_mov_b32 m0, s63
Lwo_13:
  s_add_u32 s71, s70, 7168
  buffer_load_dwordx4 v16, s[52:55], s70 offen lds
  s_add_u32 m0, m0, 1024
  s_add_u32 s72, s70, 14336
  buffer_load_dwordx4 v16, s[52:55], s71 offen lds
  s_add_u32 m0, m0, 1024
  s_add_u32 s71, s70, 21504
  buffer_load_dwordx4 v17, s[52:55], s72 offen lds
  s_add_u32 m0, m0, 1024
  s_add_u32 s70, s70, 25088
  s_mov_b32 exec_hi, 0
  buffer_load_dwordx4 v17, s[52:55], s71 offen lds
  s_mov_b32 exec_hi, -1
  s_add_u32 m0, m0, 512
  s_add_u32 s73, s73, 1
  s_cmp_lt_u32 s73, 16
  s_cbranch_scc1 Lwo_13
  s_barrier
  s_waitcnt vmcnt(0) lgkmcnt(0)
  s_barrier
  s_endpgm
Lb_ldw:
  s_sub_u32 s72, s3, 9
  s_mul_i32 s71, s67, 112
  s_lshl_b32 s70, s72, 9
  v_add_u32 v10, 0, v1
  v_add_u32 v10, s70, v10
  v_lshrrev_b32 v11, 4, v10
  v_lshrrev_b32 v12, 2, v10
  v_xor_b32 v12, v12, v11
  v_and_b32 v13, 1, v12
  v_mul_u32_u24 v13, 56, v13
  v_bfe_u32 v12, v12, 1, 1
  v_add_u32 v12, 1, v12
  v_mul_u32_u24 v12, 896, v12
  v_mul_u32_u24 v11, 2688, v11
  v_and_b32 v10, 3, v10
  v_lshlrev_b32 v10, 4, v10
  v_add3_u32 v11, v11, v12, v10
  v_add3_u32 v20, v11, v13, s71
  v_add_u32 v10, 64, v1
  v_add_u32 v10, s70, v10
  v_lshrrev_b32 v11, 4, v10
  v_lshrrev_b32 v12, 2, v10
  v_xor_b32 v12, v12, v11
  v_and_b32 v13, 1, v12
  v_mul_u32_u24 v13, 56, v13
  v_bfe_u32 v12, v12, 1, 1
  v_add_u32 v12, 1, v12
  v_mul_u32_u24 v12, 896, v12
  v_mul_u32_u24 v11, 2688, v11
  v_and_b32 v10, 3, v10
  v_lshlrev_b32 v10, 4, v10
  v_add3_u32 v11, v11, v12, v10
  v_add3_u32 v21, v11, v13, s71
  v_add_u32 v10, 128, v1
  v_add_u32 v10, s70, v10
  v_lshrrev_b32 v11, 4, v10
  v_lshrrev_b32 v12, 2, v10
  v_xor_b32 v12, v12, v11
  v_and_b32 v13, 1, v12
  v_mul_u32_u24 v13, 56, v13
  v_bfe_u32 v12, v12, 1, 1
  v_add_u32 v12, 1, v12
  v_mul_u32_u24 v12, 896, v12
  v_mul_u32_u24 v11, 2688, v11
  v_and_b32 v10, 3, v10
  v_lshlrev_b32 v10, 4, v10
  v_add3_u32 v11, v11, v12, v10
  v_add3_u32 v22, v11, v13, s71
  v_add_u32 v10, 192, v1
  v_add_u32 v10, s70, v10
  v_lshrrev_b32 v11, 4, v10
  v_lshrrev_b32 v12, 2, v10
  v_xor_b32 v12, v12, v11
  v_and_b32 v13, 1, v12
  v_mul_u32_u24 v13, 56, v13
  v_bfe_u32 v12, v12, 1, 1
  v_add_u32 v12, 1, v12
  v_mul_u32_u24 v12, 896, v12
  v_mul_u32_u24 v11, 2688, v11
  v_and_b32 v10, 3, v10
  v_lshlrev_b32 v10, 4, v10
  v_add3_u32 v11, v11, v12, v10
  v_add3_u32 v23, v11, v13, s71
  v_add_u32 v10, 256, v1
  v_add_u32 v10, s70, v10
  v_lshrrev_b32 v11, 4, v10
  v_lshrrev_b32 v12, 2, v10
  v_xor_b32 v12, v12, v11
  v_and_b32 v13, 1, v12
  v_mul_u32_u24 v13, 56, v13
  v_bfe_u32 v12, v12, 1, 1
  v_add_u32 v12, 1, v12
  v_mul_u32_u24 v12, 896, v12
  v_mul_u32_u24 v11, 2688, v11
  v_and_b32 v10, 3, v10
  v_lshlrev_b32 v10, 4, v10
  v_add3_u32 v11, v11, v12, v10
  v_add3_u32 v24, v11, v13, s71
  v_add_u32 v10, 320, v1
  v_add_u32 v10, s70, v10
  v_lshrrev_b32 v11, 4, v10
  v_lshrrev_b32 v12, 2, v10
  v_xor_b32 v12, v12, v11
  v_and_b32 v13, 1, v12
  v_mul_u32_u24 v13, 56, v13
  v_bfe_u32 v12, v12, 1, 1
  v_add_u32 v12, 1, v12
  v_mul_u32_u24 v12, 896, v12
  v_mul_u32_u24 v11, 2688, v11
  v_and_b32 v10, 3, v10
  v_lshlrev_b32 v10, 4, v10
  v_add3_u32 v11, v11, v12, v10
  v_add3_u32 v25, v11, v13, s71
  v_add_u32 v10, 384, v1
  v_add_u32 v10, s70, v10
  v_lshrrev_b32 v11, 4, v10
  v_lshrrev_b32 v12, 2, v10
  v_xor_b32 v12, v12, v11
  v_and_b32 v13, 1, v12
  v_mul_u32_u24 v13, 56, v13
  v_bfe_u32 v12, v12, 1, 1
  v_add_u32 v12, 1, v12
  v_mul_u32_u24 v12, 896, v12
  v_mul_u32_u24 v11, 2688, v11
  v_and_b32 v10, 3, v10
  v_lshlrev_b32 v10, 4, v10
  v_add3_u32 v11, v11, v12, v10
  v_add3_u32 v26, v11, v13, s71
  v_add_u32 v10, 448, v1
  v_add_u32 v10, s70, v10
  v_lshrrev_b32 v11, 4, v10
  v_lshrrev_b32 v12, 2, v10
  v_xor_b32 v12, v12, v11
  v_and_b32 v13, 1, v12
  v_mul_u32_u24 v13, 56, v13
  v_bfe_u32 v12, v12, 1, 1
  v_add_u32 v12, 1, v12
  v_mul_u32_u24 v12, 896, v12
  v_mul_u32_u24 v11, 2688, v11
  v_and_b32 v10, 3, v10
  v_lshlrev_b32 v10, 4, v10
  v_add3_u32 v11, v11, v12, v10
  v_add3_u32 v27, v11, v13, s71
  s_lshl_b32 s70, s72, 8
  v_add_u32 v10, 0, v1
  v_add_u32 v10, s70, v10
  v_lshrrev_b32 v11, 3, v10
  v_lshrrev_b32 v12, 2, v10
  v_lshrrev_b32 v13, 1, v11
  v_xor_b32 v12, v12, v13
  v_and_b32 v13, 1, v12
  v_mul_u32_u24 v13, 56, v13
  v_mul_u32_u24 v11, 2688, v11
  v_and_b32 v10, 3, v10
  v_lshlrev_b32 v10, 4, v10
  v_add3_u32 v11, v11, v13, v10
  v_add_u32 v32, s71, v11
  v_add_u32 v10, 64, v1
  v_add_u32 v10, s70, v10
  v_lshrrev_b32 v11, 3, v10
  v_lshrrev_b32 v12, 2, v10
  v_lshrrev_b32 v13, 1, v11
  v_xor_b32 v12, v12, v13
  v_and_b32 v13, 1, v12
  v_mul_u32_u24 v13, 56, v13
  v_mul_u32_u24 v11, 2688, v11
  v_and_b32 v10, 3, v10
  v_lshlrev_b32 v10, 4, v10
  v_add3_u32 v11, v11, v13, v10
  v_add_u32 v33, s71, v11
  v_add_u32 v10, 128, v1
  v_add_u32 v10, s70, v10
  v_lshrrev_b32 v11, 3, v10
  v_lshrrev_b32 v12, 2, v10
  v_lshrrev_b32 v13, 1, v11
  v_xor_b32 v12, v12, v13
  v_and_b32 v13, 1, v12
  v_mul_u32_u24 v13, 56, v13
  v_mul_u32_u24 v11, 2688, v11
  v_and_b32 v10, 3, v10
  v_lshlrev_b32 v10, 4, v10
  v_add3_u32 v11, v11, v13, v10
  v_add_u32 v34, s71, v11
  v_add_u32 v10, 192, v1
  v_add_u32 v10, s70, v10
  v_lshrrev_b32 v11, 3, v10
  v_lshrrev_b32 v12, 2, v10
  v_lshrrev_b32 v13, 1, v11
  v_xor_b32 v12, v12, v13
  v_and_b32 v13, 1, v12
  v_mul_u32_u24 v13, 56, v13
  v_mul_u32_u24 v11, 2688, v11
  v_and_b32 v10, 3, v10
  v_lshlrev_b32 v10, 4, v10
  v_add3_u32 v11, v11, v13, v10
  v_add_u32 v35, s71, v11
  s_mul_i32 s76, s74, 172032
  s_lshl_b32 s71, s72, 13
  s_lshl_b32 s74, s72, 12
  s_mov_b32 s77, 49152
  s_mov_b32 s73, 0
  s_waitcnt lgkmcnt(0)
  s_mov_b32 s44, s28
  s_and_b32 s45, s29, 0xffff
  s_mov_b32 s46, 1204224
  s_mov_b32 s47, 0x20000
  s_mov_b32 s60, s30
  s_and_b32 s61, s31, 0xffff
  s_mov_b32 s62, 25088
  s_mov_b32 s63, 0x20000
Lldw_14:
  s_cmp_lt_u32 s73, 2
  s_cbranch_scc1 Lldwn_15
  s_waitcnt vmcnt(8)
  s_barrier
Lldwn_15:
  s_add_u32 m0, s77, s71
  s_nop 0
  buffer_load_dwordx4 v20, s[44:47], s76 offen lds
  s_add_u32 m0, m0, 1024
  s_nop 0
  buffer_load_dwordx4 v21, s[44:47], s76 offen lds
  s_add_u32 m0, m0, 1024
  s_nop 0
  buffer_load_dwordx4 v22, s[44:47], s76 offen lds
  s_add_u32 m0, m0, 1024
  s_nop 0
  buffer_load_dwordx4 v23, s[44:47], s76 offen lds
  s_add_u32 m0, m0, 1024
  s_nop 0
  buffer_load_dwordx4 v24, s[44:47], s76 offen lds
  s_add_u32 m0, m0, 1024
  s_nop 0
  buffer_load_dwordx4 v25, s[44:47], s76 offen lds
  s_add_u32 m0, m0, 1024
  s_nop 0
  buffer_load_dwordx4 v26, s[44:47], s76 offen lds
  s_add_u32 m0, m0, 1024
  s_nop 0
  buffer_load_dwordx4 v27, s[44:47], s76 offen lds
  s_add_u32 s76, s76, 172032
  s_cmp_eq_u32 s76, 1204224
  s_cselect_b32 s76, 0, s76
  s_add_u32 s77, s77, 16384
  s_cmp_eq_u32 s77, 98304
  s_cselect_b32 s77, 49152, s77
  s_add_u32 s73, s73, 1
  s_cmp_lt_u32 s73, 7
  s_cbranch_scc1 Lldw_14
  s_waitcnt vmcnt(8)
  s_barrier
  s_add_u32 m0, s77, s74
  s_nop 0
  buffer_load_dwordx4 v32, s[44:47], s76 offen lds
  s_add_u32 m0, m0, 1024
  s_nop 0
  buffer_load_dwordx4 v33, s[44:47], s76 offen lds
  s_add_u32 m0, m0, 1024
  s_nop 0
  buffer_load_dwordx4 v34, s[44:47], s76 offen lds
  s_add_u32 m0, m0, 1024
  s_nop 0
  buffer_load_dwordx4 v35, s[44:47], s76 offen lds
  s_add_u32 s76, s76, 172032
  s_cmp_eq_u32 s76, 1204224
  s_cselect_b32 s76, 0, s76
  s_add_u32 s77, s77, 16384
  s_cmp_eq_u32 s77, 98304
  s_cselect_b32 s77, 49152, s77
  v_lshlrev_b32 v10, 4, v1
  s_cmp_lg_u32 s3, 9
  s_cbranch_scc1 Lnphi_16
  s_mul_i32 s70, s67, 3136
  s_mov_b32 m0, 153600
  s_nop 0
  buffer_load_dwordx4 v10, s[60:63], s70 offen offset:0 lds
  buffer_load_dwordx4 v10, s[60:63], s70 offen offset:1024 lds
  buffer_load_dwordx4 v10, s[60:63], s70 offen offset:2048 lds
  buffer_load_dwordx4 v10, s[60:63], s70 offen offset:3072 lds
Lnphi_16:
  s_waitcnt vmcnt(4)
  s_barrier
  s_add_u32 m0, s77, s74
  s_nop 0
  buffer_load_dwordx4 v32, s[44:47], s76 offen lds
  s_add_u32 m0, m0, 1024
  s_nop 0
  buffer_load_dwordx4 v33, s[44:47], s76 offen lds
  s_add_u32 m0, m0, 1024
  s_nop 0
  buffer_load_dwordx4 v34, s[44:47], s76 offen lds
  s_add_u32 m0, m0, 1024
  s_nop 0
  buffer_load_dwordx4 v35, s[44:47], s76 offen lds
  s_add_u32 s76, s76, 172032
  s_cmp_eq_u32 s76, 1204224
  s_cselect_b32 s76, 0, s76
  s_add_u32 s77, s77, 16384
  s_cmp_eq_u32 s77, 98304
  s_cselect_b32 s77, 49152, s77
  s_waitcnt vmcnt(4)
  s_barrier
  s_add_u32 m0, s77, s74
  s_nop 0
  buffer_load_dwordx4 v32, s[44:47], s76 offen lds
  s_add_u32 m0, m0, 1024
  s_nop 0
  buffer_load_dwordx4 v33, s[44:47], s76 offen lds
  s_add_u32 m0, m0, 1024
  s_nop 0
  buffer_load_dwordx4 v34, s[44:47], s76 offen lds
  s_add_u32 m0, m0, 1024
  s_nop 0
  buffer_load_dwordx4 v35, s[44:47], s76 offen lds
  s_add_u32 s76, s76, 172032
  s_cmp_eq_u32 s76, 1204224
  s_cselect_b32 s76, 0, s76
  s_add_u32 s77, s77, 16384
  s_cmp_eq_u32 s77, 98304
  s_cselect_b32 s77, 49152, s77
  s_barrier
  s_mov_b32 s73, 10
Lldq_17:
  s_waitcnt vmcnt(4)
  s_barrier
  s_add_u32 m0, s77, s74
  s_nop 0
  buffer_load_dwordx4 v32, s[44:47], s76 offen lds
  s_add_u32 m0, m0, 1024
  s_nop 0
  buffer_load_dwordx4 v33, s[44:47], s76 offen lds
  s_add_u32 m0, m0, 1024
  s_nop 0
  buffer_load_dwordx4 v34, s[44:47], s76 offen lds
  s_add_u32 m0, m0, 1024
  s_nop 0
  buffer_load_dwordx4 v35, s[44:47], s76 offen lds
  s_add_u32 s76, s76, 172032
  s_cmp_eq_u32 s76, 1204224
  s_cselect_b32 s76, 0, s76
  s_add_u32 s77, s77, 16384
  s_cmp_eq_u32 s77, 98304
  s_cselect_b32 s77, 49152, s77
  s_add_u32 s73, s73, 1
  s_cmp_lt_u32 s73, 14
  s_cbranch_scc1 Lldq_17
  s_waitcnt vmcnt(4)
  s_barrier
  s_waitcnt vmcnt(0)
  s_barrier
  s_barrier
  s_endpgm
Lb_w11:
  s_waitcnt lgkmcnt(0)
  s_mov_b32 s52, s32
  s_and_b32 s53, s33, 0xffff
  s_mov_b32 s54, 401408
  s_mov_b32 s55, 0x20000
  s_mov_b32 s48, s38
  s_and_b32 s49, s39, 0xffff
  s_mov_b32 s50, 268435456
  s_mov_b32 s51, 0x20000
  s_load_dword s5, s[38:39], 0
  s_mul_i32 s70, s65, 98
  v_add_u32 v10, s70, v1
  v_lshlrev_b32 v10, 7, v10
  buffer_load_dword v20, v10, s[52:55], 0 offen
  v_min_u32 v11, 33, v1
  s_add_u32 s70, s70, 64
  v_add_u32 v11, s70, v11
  v_lshlrev_b32 v11, 7, v11
  buffer_load_dword v21, v11, s[52:55], 0 offen
  v_lshlrev_b32 v10, 4, v1
  v_mov_b32 v16, -1
  v_mov_b32 v17, -1
  v_mov_b32 v18, -1
  v_mov_b32 v19, -1
  s_barrier
  s_lshl_b32 s71, s67, 5
  s_add_u32 s71, s71, s66
  s_lshl_b32 s71, s71, 12
  s_add_u32 s71, s71, 1048576
  buffer_store_dwordx4 v[16:19], v10, s[48:51], s71 offen offset:0 sc1
  buffer_store_dwordx4 v[16:19], v10, s[48:51], s71 offen offset:1024 sc1
  buffer_store_dwordx4 v[16:19], v10, s[48:51], s71 offen offset:2048 sc1
  buffer_store_dwordx4 v[16:19], v10, s[48:51], s71 offen offset:3072 sc1
  s_add_u32 s71, s71, 65536
  buffer_store_dwordx4 v[16:19], v10, s[48:51], s71 offen offset:0 sc1
  buffer_store_dwordx4 v[16:19], v10, s[48:51], s71 offen offset:1024 sc1
  buffer_store_dwordx4 v[16:19], v10, s[48:51], s71 offen offset:2048 sc1
  buffer_store_dwordx4 v[16:19], v10, s[48:51], s71 offen offset:3072 sc1
  s_lshl_b32 s71, s66, 7
  s_lshl_b32 s70, s67, 1
  s_add_u32 s71, s71, s70
  s_lshl_b32 s71, s71, 10
  s_add_u32 s71, s71, 2097152
  buffer_store_dwordx4 v[16:19], v10, s[48:51], s71 offen sc1
  buffer_store_dwordx4 v[16:19], v10, s[48:51], s71 offen offset:1024 sc1
  s_add_u32 s71, s71, 16384
  buffer_store_dwordx4 v[16:19], v10, s[48:51], s71 offen sc1
  buffer_store_dwordx4 v[16:19], v10, s[48:51], s71 offen offset:1024 sc1
  s_add_u32 s71, s71, 16384
  buffer_store_dwordx4 v[16:19], v10, s[48:51], s71 offen sc1
  buffer_store_dwordx4 v[16:19], v10, s[48:51], s71 offen offset:1024 sc1
  s_add_u32 s71, s71, 16384
  buffer_store_dwordx4 v[16:19], v10, s[48:51], s71 offen sc1
  buffer_store_dwordx4 v[16:19], v10, s[48:51], s71 offen offset:1024 sc1
  s_add_u32 s71, s71, 16384
  buffer_store_dwordx4 v[16:19], v10, s[48:51], s71 offen sc1
  buffer_store_dwordx4 v[16:19], v10, s[48:51], s71 offen offset:1024 sc1
  s_add_u32 s71, s71, 16384
  buffer_store_dwordx4 v[16:19], v10, s[48:51], s71 offen sc1
  buffer_store_dwordx4 v[16:19], v10, s[48:51], s71 offen offset:1024 sc1
  s_add_u32 s71, s71, 16384
  buffer_store_dwordx4 v[16:19], v10, s[48:51], s71 offen sc1
  buffer_store_dwordx4 v[16:19], v10, s[48:51], s71 offen offset:1024 sc1
  s_add_u32 s71, s71, 16384
  buffer_store_dwordx4 v[16:19], v10, s[48:51], s71 offen sc1
  buffer_store_dwordx4 v[16:19], v10, s[48:51], s71 offen offset:1024 sc1
  s_lshl_b32 s71, s67, 13
  s_lshl_b32 s70, s66, 9
  s_add_u32 s71, s71, s70
  s_add_u32 s71, s71, 524288
  s_mov_b32 exec_hi, 0
  buffer_store_dwordx4 v[16:19], v10, s[48:51], s71 offen sc1
  s_mov_b32 exec_hi, -1
  s_barrier
  s_barrier
  s_waitcnt vmcnt(0) lgkmcnt(0)
  s_mul_i32 s4, s5, 0x9e3779b1
  s_add_u32 s4, s4, 0x85ebca6b
  s_lshl_b32 s72, s67, 4
  s_add_u32 s72, s72, s66
  s_lshl_b32 s72, s72, 7
  s_add_u32 s72, s72, 69632
  v_mov_b32 v11, s72
  v_mov_b32 v12, s4
  s_mov_b64 exec, 1
  buffer_store_dword v12, v11, s[48:51], 0 offen sc1
  s_mov_b64 exec, -1
  s_barrier
  s_barrier
  s_barrier
  s_barrier
  s_barrier
  v_and_b32 v10, 15, v1
  s_lshl_b32 s70, s67, 4
  v_add_u32 v11, s70, v10
  v_lshlrev_b32 v12, 4, v10
  s_lshr_b32 s71, s68, 1
  v_add_u32 v12, s71, v12
  v_cmp_lt_u32 vcc, 15, v1
  s_nop 1
  v_cndmask_b32 v11, v11, v12, vcc
  v_lshlrev_b32 v11, 7, v11
  v_add_u32 v15, 69632, v11
  s_mov_b64 exec, 0xffffff
  s_mov_b32 s6, 0
Lpoll_18:
  buffer_load_dword v14, v15, s[48:51], 0 offen sc1
  s_add_u32 s6, s6, 1
  s_waitcnt vmcnt(0)
  v_cmp_ne_u32 vcc, s4, v14
  s_cmp_gt_u32 s6, 100000
  s_cbranch_scc1 Lpdone_19
  s_cbranch_vccz Lpdone_19
  s_mov_b64 exec, vcc
  s_sleep 4
  s_branch Lpoll_18
Lpdone_19:
  s_mov_b64 exec, -1
  s_barrier
  s_endpgm
Lfinal:
  s_lshl_b32 s72, s68, 2
  s_add_u32 s72, s72, s3
  s_lshl_b32 s72, s72, 14
  s_add_u32 s72, s72, 2097152
  v_and_b32 v10, 15, v1
  v_lshlrev_b32 v10, 10, v10
  v_lshlrev_b32 v11, 4, v1
  v_lshrrev_b32 v6, 4, v1
  v_and_b32 v7, 1, v6
  v_lshrrev_b32 v6, 1, v6
  v_lshrrev_b32 v8, 2, v1
  v_and_b32 v8, 3, v8
  v_lshlrev_b32 v9, 4, v7
  v_lshl_add_u32 v9, v6, 2, v9
  v_add_u32 v9, v9, v8
  v_lshlrev_b32 v9, 7, v9
  v_and_b32 v6, 3, v1
  v_lshl_add_u32 v9, v6, 3, v9
  v_add_u32 v9, s63, v9
  v_lshrrev_b32 v8, 1, v8
  v_lshl_add_u32 v8, v7, 1, v8
  v_xor_b32 v6, 0, v8
  v_lshl_add_u32 v2, v6, 5, v9
  v_xor_b32 v6, 1, v8
  v_lshl_add_u32 v3, v6, 5, v9
  v_xor_b32 v6, 2, v8
  v_lshl_add_u32 v4, v6, 5, v9
  v_xor_b32 v6, 3, v8
  v_lshl_add_u32 v5, v6, 5, v9
  s_cmp_lg_u32 s3, 0
  s_cbranch_scc1 Lnop_20
  s_mov_b64 exec, 0xffff
  s_mov_b32 s6, 0
Lsp_21:
  buffer_load_dword v12, v10, s[48:51], s72 offen sc1
  s_add_u32 s6, s6, 1
  s_waitcnt vmcnt(0)
  v_cmp_eq_u32 vcc, -1, v12
  s_cmp_gt_u32 s6, 100000
  s_cbranch_scc1 Lsdone_22
  s_cbranch_vccz Lsdone_22
  s_mov_b64 exec, vcc
  s_sleep 6
  s_branch Lsp_21
Lsdone_22:
  s_mov_b64 exec, -1
Lnop_20:
  s_barrier
  s_mov_b32 s73, 0
Lh2_23:
  s_mov_b32 s70, s72
  buffer_load_dwordx4 v[64:67], v11, s[48:51], s70 offen offset:0 sc1
  buffer_load_dwordx4 v[68:71], v11, s[48:51], s70 offen offset:1024 sc1
  buffer_load_dwordx4 v[72:75], v11, s[48:51], s70 offen offset:2048 sc1
  buffer_load_dwordx4 v[76:79], v11, s[48:51], s70 offen offset:3072 sc1
  s_add_u32 s70, s70, 4096
  buffer_load_dwordx4 v[80:83], v11, s[48:51], s70 offen offset:0 sc1
  buffer_load_dwordx4 v[84:87], v11, s[48:51], s70 offen offset:1024 sc1
  buffer_load_dwordx4 v[88:91], v11, s[48:51], s70 offen offset:2048 sc1
  buffer_load_dwordx4 v[92:95], v11, s[48:51], s70 offen offset:3072 sc1
  s_add_u32 s70, s70, 4096
  buffer_load_dwordx4 v[96:99], v11, s[48:51], s70 offen offset:0 sc1
  buffer_load_dwordx4 v[100:103], v11, s[48:51], s70 offen offset:1024 sc1
  buffer_load_dwordx4 v[104:107], v11, s[48:51], s70 offen offset:2048 sc1
  buffer_load_dwordx4 v[108:111], v11, s[48:51], s70 offen offset:3072 sc1
  s_add_u32 s70, s70, 4096
  buffer_load_dwordx4 v[112:115], v11, s[48:51], s70 offen offset:0 sc1
  buffer_load_dwordx4 v[116:119], v11, s[48:51], s70 offen offset:1024 sc1
  buffer_load_dwordx4 v[120:123], v11, s[48:51], s70 offen offset:2048 sc1
  buffer_load_dwordx4 v[124:127], v11, s[48:51], s70 offen offset:3072 sc1
  ds_read_b64_tr_b16 v[16:17], v2 offset:0
  ds_read_b64_tr_b16 v[18:19], v2 offset:1024
  ds_read_b64_tr_b16 v[20:21], v3 offset:0
  ds_read_b64_tr_b16 v[22:23], v3 offset:1024
  ds_read_b64_tr_b16 v[24:25], v4 offset:0
  ds_read_b64_tr_b16 v[26:27], v4 offset:1024
  ds_read_b64_tr_b16 v[28:29], v5 offset:0
  ds_read_b64_tr_b16 v[30:31], v5 offset:1024
  s_mov_b32 s77, 0
  ds_read_b64_tr_b16 v[32:33], v2 offset:3584
  ds_read_b64_tr_b16 v[34:35], v2 offset:4608
  ds_read_b64_tr_b16 v[36:37], v3 offset:3584
  ds_read_b64_tr_b16 v[38:39], v3 offset:4608
  ds_read_b64_tr_b16 v[40:41], v4 offset:3584
  ds_read_b64_tr_b16 v[42:43], v4 offset:4608
  ds_read_b64_tr_b16 v[44:45], v5 offset:3584
  ds_read_b64_tr_b16 v[46:47], v5 offset:4608
  s_waitcnt vmcnt(15)
  s_waitcnt lgkmcnt(8)
  v_mfma_f32_16x16x32_bf16 v[48:51], v[16:19], v[64:67], 0
  v_mfma_f32_16x16x32_bf16 v[52:55], v[20:23], v[64:67], 0
  v_mfma_f32_16x16x32_bf16 v[56:59], v[24:27], v[64:67], 0
  v_mfma_f32_16x16x32_bf16 v[60:63], v[28:31], v[64:67], 0
  ds_read_b64_tr_b16 v[16:17], v2 offset:7168
  ds_read_b64_tr_b16 v[18:19], v2 offset:8192
  ds_read_b64_tr_b16 v[20:21], v3 offset:7168
  ds_read_b64_tr_b16 v[22:23], v3 offset:8192
  ds_read_b64_tr_b16 v[24:25], v4 offset:7168
  ds_read_b64_tr_b16 v[26:27], v4 offset:8192
  ds_read_b64_tr_b16 v[28:29], v5 offset:7168
  ds_read_b64_tr_b16 v[30:31], v5 offset:8192
  s_waitcnt vmcnt(14)
  s_waitcnt lgkmcnt(8)
  v_mfma_f32_16x16x32_bf16 v[48:51], v[32:35], v[68:71], v[48:51]
  v_mfma_f32_16x16x32_bf16 v[52:55], v[36:39], v[68:71], v[52:55]
  v_mfma_f32_16x16x32_bf16 v[56:59], v[40:43], v[68:71], v[56:59]
  v_mfma_f32_16x16x32_bf16 v[60:63], v[44:47], v[68:71], v[60:63]
  ds_read_b64_tr_b16 v[32:33], v2 offset:10752
  ds_read_b64_tr_b16 v[34:35], v2 offset:11776
  ds_read_b64_tr_b16 v[36:37], v3 offset:10752
  ds_read_b64_tr_b16 v[38:39], v3 offset:11776
  ds_read_b64_tr_b16 v[40:41], v4 offset:10752
  ds_read_b64_tr_b16 v[42:43], v4 offset:11776
  ds_read_b64_tr_b16 v[44:45], v5 offset:10752
  ds_read_b64_tr_b16 v[46:47], v5 offset:11776
  s_waitcnt vmcnt(13)
  s_waitcnt lgkmcnt(8)
  v_mfma_f32_16x16x32_bf16 v[48:51], v[16:19], v[72:75], v[48:51]
  v_mfma_f32_16x16x32_bf16 v[52:55], v[20:23], v[72:75], v[52:55]
  v_mfma_f32_16x16x32_bf16 v[56:59], v[24:27], v[72:75], v[56:59]
  v_mfma_f32_16x16x32_bf16 v[60:63], v[28:31], v[72:75], v[60:63]
  ds_read_b64_tr_b16 v[16:17], v2 offset:14336
  ds_read_b64_tr_b16 v[18:19], v2 offset:15360
  ds_read_b64_tr_b16 v[20:21], v3 offset:14336
  ds_read_b64_tr_b16 v[22:23], v3 offset:15360
  ds_read_b64_tr_b16 v[24:25], v4 offset:14336
  ds_read_b64_tr_b16 v[26:27], v4 offset:15360
  ds_read_b64_tr_b16 v[28:29], v5 offset:14336
  ds_read_b64_tr_b16 v[30:31], v5 offset:15360
  s_waitcnt vmcnt(12)
  s_waitcnt lgkmcnt(8)
  v_mfma_f32_16x16x32_bf16 v[48:51], v[32:35], v[76:79], v[48:51]
  v_mfma_f32_16x16x32_bf16 v[52:55], v[36:39], v[76:79], v[52:55]
  v_mfma_f32_16x16x32_bf16 v[56:59], v[40:43], v[76:79], v[56:59]
  v_mfma_f32_16x16x32_bf16 v[60:63], v[44:47], v[76:79], v[60:63]
  ds_read_b64_tr_b16 v[32:33], v2 offset:17920
  ds_read_b64_tr_b16 v[34:35], v2 offset:18944
  ds_read_b64_tr_b16 v[36:37], v3 offset:17920
  ds_read_b64_tr_b16 v[38:39], v3 offset:18944
  ds_read_b64_tr_b16 v[40:41], v4 offset:17920
  ds_read_b64_tr_b16 v[42:43], v4 offset:18944
  ds_read_b64_tr_b16 v[44:45], v5 offset:17920
  ds_read_b64_tr_b16 v[46:47], v5 offset:18944
  s_waitcnt vmcnt(11)
  s_waitcnt lgkmcnt(8)
  v_mfma_f32_16x16x32_bf16 v[48:51], v[16:19], v[80:83], v[48:51]
  v_mfma_f32_16x16x32_bf16 v[52:55], v[20:23], v[80:83], v[52:55]
  v_mfma_f32_16x16x32_bf16 v[56:59], v[24:27], v[80:83], v[56:59]
  v_mfma_f32_16x16x32_bf16 v[60:63], v[28:31], v[80:83], v[60:63]
  ds_read_b64_tr_b16 v[16:17], v2 offset:21504
  ds_read_b64_tr_b16 v[18:19], v2 offset:22528
  ds_read_b64_tr_b16 v[20:21], v3 offset:21504
  ds_read_b64_tr_b16 v[22:23], v3 offset:22528
  ds_read_b64_tr_b16 v[24:25], v4 offset:21504
  ds_read_b64_tr_b16 v[26:27], v4 offset:22528
  ds_read_b64_tr_b16 v[28:29], v5 offset:21504
  ds_read_b64_tr_b16 v[30:31], v5 offset:22528
  s_waitcnt vmcnt(10)
  s_waitcnt lgkmcnt(8)
  v_mfma_f32_16x16x32_bf16 v[48:51], v[32:35], v[84:87], v[48:51]
  v_mfma_f32_16x16x32_bf16 v[52:55], v[36:39], v[84:87], v[52:55]
  v_mfma_f32_16x16x32_bf16 v[56:59], v[40:43], v[84:87], v[56:59]
  v_mfma_f32_16x16x32_bf16 v[60:63], v[44:47], v[84:87], v[60:63]
  ds_read_b64_tr_b16 v[32:33], v2 offset:25088
  ds_read_b64_tr_b16 v[34:35], v2 offset:26112
  ds_read_b64_tr_b16 v[36:37], v3 offset:25088
  ds_read_b64_tr_b16 v[38:39], v3 offset:26112
  ds_read_b64_tr_b16 v[40:41], v4 offset:25088
  ds_read_b64_tr_b16 v[42:43], v4 offset:26112
  ds_read_b64_tr_b16 v[44:45], v5 offset:25088
  ds_read_b64_tr_b16 v[46:47], v5 offset:26112
  s_waitcnt vmcnt(9)
  s_waitcnt lgkmcnt(8)
  v_mfma_f32_16x16x32_bf16 v[48:51], v[16:19], v[88:91], v[48:51]
  v_mfma_f32_16x16x32_bf16 v[52:55], v[20:23], v[88:91], v[52:55]
  v_mfma_f32_16x16x32_bf16 v[56:59], v[24:27], v[88:91], v[56:59]
  v_mfma_f32_16x16x32_bf16 v[60:63], v[28:31], v[88:91], v[60:63]
  ds_read_b64_tr_b16 v[16:17], v2 offset:28672
  ds_read_b64_tr_b16 v[18:19], v2 offset:29696
  ds_read_b64_tr_b16 v[20:21], v3 offset:28672
  ds_read_b64_tr_b16 v[22:23], v3 offset:29696
  ds_read_b64_tr_b16 v[24:25], v4 offset:28672
  ds_read_b64_tr_b16 v[26:27], v4 offset:29696
  ds_read_b64_tr_b16 v[28:29], v5 offset:28672
  ds_read_b64_tr_b16 v[30:31], v5 offset:29696
  s_waitcnt vmcnt(8)
  s_waitcnt lgkmcnt(8)
  v_mfma_f32_16x16x32_bf16 v[48:51], v[32:35], v[92:95], v[48:51]
  v_mfma_f32_16x16x32_bf16 v[52:55], v[36:39], v[92:95], v[52:55]
  v_mfma_f32_16x16x32_bf16 v[56:59], v[40:43], v[92:95], v[56:59]
  v_mfma_f32_16x16x32_bf16 v[60:63], v[44:47], v[92:95], v[60:63]
  ds_read_b64_tr_b16 v[32:33], v2 offset:32256
  ds_read_b64_tr_b16 v[34:35], v2 offset:33280
  ds_read_b64_tr_b16 v[36:37], v3 offset:32256
  ds_read_b64_tr_b16 v[38:39], v3 offset:33280
  ds_read_b64_tr_b16 v[40:41], v4 offset:32256
  ds_read_b64_tr_b16 v[42:43], v4 offset:33280
  ds_read_b64_tr_b16 v[44:45], v5 offset:32256
  ds_read_b64_tr_b16 v[46:47], v5 offset:33280
  s_waitcnt vmcnt(7)
  s_waitcnt lgkmcnt(8)
  v_mfma_f32_16x16x32_bf16 v[48:51], v[16:19], v[96:99], v[48:51]
  v_mfma_f32_16x16x32_bf16 v[52:55], v[20:23], v[96:99], v[52:55]
  v_mfma_f32_16x16x32_bf16 v[56:59], v[24:27], v[96:99], v[56:59]
  v_mfma_f32_16x16x32_bf16 v[60:63], v[28:31], v[96:99], v[60:63]
  ds_read_b64_tr_b16 v[16:17], v2 offset:35840
  ds_read_b64_tr_b16 v[18:19], v2 offset:36864
  ds_read_b64_tr_b16 v[20:21], v3 offset:35840
  ds_read_b64_tr_b16 v[22:23], v3 offset:36864
  ds_read_b64_tr_b16 v[24:25], v4 offset:35840
  ds_read_b64_tr_b16 v[26:27], v4 offset:36864
  ds_read_b64_tr_b16 v[28:29], v5 offset:35840
  ds_read_b64_tr_b16 v[30:31], v5 offset:36864
  s_waitcnt vmcnt(6)
  s_waitcnt lgkmcnt(8)
  v_mfma_f32_16x16x32_bf16 v[48:51], v[32:35], v[100:103], v[48:51]
  v_mfma_f32_16x16x32_bf16 v[52:55], v[36:39], v[100:103], v[52:55]
  v_mfma_f32_16x16x32_bf16 v[56:59], v[40:43], v[100:103], v[56:59]
  v_mfma_f32_16x16x32_bf16 v[60:63], v[44:47], v[100:103], v[60:63]
  ds_read_b64_tr_b16 v[32:33], v2 offset:39424
  ds_read_b64_tr_b16 v[34:35], v2 offset:40448
  ds_read_b64_tr_b16 v[36:37], v3 offset:39424
  ds_read_b64_tr_b16 v[38:39], v3 offset:40448
  ds_read_b64_tr_b16 v[40:41], v4 offset:39424
  ds_read_b64_tr_b16 v[42:43], v4 offset:40448
  ds_read_b64_tr_b16 v[44:45], v5 offset:39424
  ds_read_b64_tr_b16 v[46:47], v5 offset:40448
  s_waitcnt vmcnt(5)
  s_waitcnt lgkmcnt(8)
  v_mfma_f32_16x16x32_bf16 v[48:51], v[16:19], v[104:107], v[48:51]
  v_mfma_f32_16x16x32_bf16 v[52:55], v[20:23], v[104:107], v[52:55]
  v_mfma_f32_16x16x32_bf16 v[56:59], v[24:27], v[104:107], v[56:59]
  v_mfma_f32_16x16x32_bf16 v[60:63], v[28:31], v[104:107], v[60:63]
  ds_read_b64_tr_b16 v[16:17], v2 offset:43008
  ds_read_b64_tr_b16 v[18:19], v2 offset:44032
  ds_read_b64_tr_b16 v[20:21], v3 offset:43008
  ds_read_b64_tr_b16 v[22:23], v3 offset:44032
  ds_read_b64_tr_b16 v[24:25], v4 offset:43008
  ds_read_b64_tr_b16 v[26:27], v4 offset:44032
  ds_read_b64_tr_b16 v[28:29], v5 offset:43008
  ds_read_b64_tr_b16 v[30:31], v5 offset:44032
  s_waitcnt vmcnt(4)
  s_waitcnt lgkmcnt(8)
  v_mfma_f32_16x16x32_bf16 v[48:51], v[32:35], v[108:111], v[48:51]
  v_mfma_f32_16x16x32_bf16 v[52:55], v[36:39], v[108:111], v[52:55]
  v_mfma_f32_16x16x32_bf16 v[56:59], v[40:43], v[108:111], v[56:59]
  v_mfma_f32_16x16x32_bf16 v[60:63], v[44:47], v[108:111], v[60:63]
  ds_read_b64_tr_b16 v[32:33], v2 offset:46592
  ds_read_b64_tr_b16 v[34:35], v2 offset:47616
  ds_read_b64_tr_b16 v[36:37], v3 offset:46592
  ds_read_b64_tr_b16 v[38:39], v3 offset:47616
  ds_read_b64_tr_b16 v[40:41], v4 offset:46592
  ds_read_b64_tr_b16 v[42:43], v4 offset:47616
  ds_read_b64_tr_b16 v[44:45], v5 offset:46592
  ds_read_b64_tr_b16 v[46:47], v5 offset:47616
  s_waitcnt vmcnt(3)
  s_waitcnt lgkmcnt(8)
  v_mfma_f32_16x16x32_bf16 v[48:51], v[16:19], v[112:115], v[48:51]
  v_mfma_f32_16x16x32_bf16 v[52:55], v[20:23], v[112:115], v[52:55]
  v_mfma_f32_16x16x32_bf16 v[56:59], v[24:27], v[112:115], v[56:59]
  v_mfma_f32_16x16x32_bf16 v[60:63], v[28:31], v[112:115], v[60:63]
  ds_read_b64_tr_b16 v[16:17], v2 offset:50176
  ds_read_b64_tr_b16 v[18:19], v2 offset:51200
  ds_read_b64_tr_b16 v[20:21], v3 offset:50176
  ds_read_b64_tr_b16 v[22:23], v3 offset:51200
  ds_read_b64_tr_b16 v[24:25], v4 offset:50176
  ds_read_b64_tr_b16 v[26:27], v4 offset:51200
  ds_read_b64_tr_b16 v[28:29], v5 offset:50176
  ds_read_b64_tr_b16 v[30:31], v5 offset:51200
  s_waitcnt vmcnt(2)
  s_waitcnt lgkmcnt(8)
  v_mfma_f32_16x16x32_bf16 v[48:51], v[32:35], v[116:119], v[48:51]
  v_mfma_f32_16x16x32_bf16 v[52:55], v[36:39], v[116:119], v[52:55]
  v_mfma_f32_16x16x32_bf16 v[56:59], v[40:43], v[116:119], v[56:59]
  v_mfma_f32_16x16x32_bf16 v[60:63], v[44:47], v[116:119], v[60:63]
  ds_read_b64_tr_b16 v[32:33], v2 offset:53760
  ds_read_b64_tr_b16 v[34:35], v2 offset:54784
  ds_read_b64_tr_b16 v[36:37], v3 offset:53760
  ds_read_b64_tr_b16 v[38:39], v3 offset:54784
  ds_read_b64_tr_b16 v[40:41], v4 offset:53760
  ds_read_b64_tr_b16 v[42:43], v4 offset:54784
  ds_read_b64_tr_b16 v[44:45], v5 offset:53760
  ds_read_b64_tr_b16 v[46:47], v5 offset:54784
  s_waitcnt vmcnt(1)
  s_waitcnt lgkmcnt(8)
  v_mfma_f32_16x16x32_bf16 v[48:51], v[16:19], v[120:123], v[48:51]
  v_mfma_f32_16x16x32_bf16 v[52:55], v[20:23], v[120:123], v[52:55]
  v_mfma_f32_16x16x32_bf16 v[56:59], v[24:27], v[120:123], v[56:59]
  v_mfma_f32_16x16x32_bf16 v[60:63], v[28:31], v[120:123], v[60:63]
  s_waitcnt vmcnt(0)
  s_waitcnt lgkmcnt(0)
  v_mfma_f32_16x16x32_bf16 v[48:51], v[32:35], v[124:127], v[48:51]
  v_mfma_f32_16x16x32_bf16 v[52:55], v[36:39], v[124:127], v[52:55]
  v_mfma_f32_16x16x32_bf16 v[56:59], v[40:43], v[124:127], v[56:59]
  v_mfma_f32_16x16x32_bf16 v[60:63], v[44:47], v[124:127], v[60:63]
  s_branch Lfdone_25
Lfdone_25:
  s_nop 7
  v_add_f32 v6, v48, v52
  v_add_f32 v7, v56, v60
  v_add_f32 v6, v6, v7
  s_add_u32 s73, s73, 1
  v_cmp_u_f32 vcc, v6, v6
  s_cmp_gt_u32 s73, 12500
  s_cbranch_scc1 Lh2d_24
  s_cbranch_vccnz Lh2_23
Lh2d_24:
  s_mov_b32 s56, s34
  s_and_b32 s57, s35, 0xffff
  s_mov_b32 s58, 3670016
  s_mov_b32 s59, 0x20000
  v_cvt_pk_bf16_f32 v16, v48, v49
  v_cvt_pk_bf16_f32 v17, v50, v51
  v_cvt_pk_bf16_f32 v18, v52, v53
  v_cvt_pk_bf16_f32 v19, v54, v55
  v_cvt_pk_bf16_f32 v20, v56, v57
  v_cvt_pk_bf16_f32 v21, v58, v59
  v_cvt_pk_bf16_f32 v22, v60, v61
  v_cvt_pk_bf16_f32 v23, v62, v63
  v_and_b32 v10, 15, v1
  s_lshl_b32 s70, s68, 6
  s_lshl_b32 s71, s3, 4
  s_add_u32 s70, s70, s71
  v_add_u32 v10, s70, v10
  v_mul_u32_u24 v10, 1792, v10
  v_lshrrev_b32 v12, 4, v1
  v_permlane16_swap_b32 v16, v18
  v_permlane16_swap_b32 v17, v19
  v_permlane16_swap_b32 v20, v22
  v_permlane16_swap_b32 v21, v23
  v_and_b32 v13, 1, v12
  v_lshlrev_b32 v13, 5, v13
  v_lshrrev_b32 v12, 1, v12
  v_lshlrev_b32 v12, 4, v12
  v_add3_u32 v10, v10, v12, v13
  s_lshl_b32 s70, s69, 7
  s_add_u32 s70, s70, 896
  buffer_store_dwordx4 v[16:19], v10, s[56:59], s70 offen sc1
  buffer_store_dwordx4 v[20:23], v10, s[56:59], s70 offen offset:64 sc1
  s_or_b32 s70, s2, s3
  s_cmp_lg_u32 s70, 0
  s_cbranch_scc1 Lnoep_26
  s_load_dword s5, s[38:39], 0
  v_mov_b32 v30, 0
  s_mov_b32 s6, 0
Leb_27:
  global_load_dword v31, v30, s[36:37] sc1
  s_add_u32 s6, s6, 1
  s_waitcnt vmcnt(0) lgkmcnt(0)
  v_cmp_gt_u32 vcc, 128, v31
  s_cmp_gt_u32 s6, 100000
  s_cbranch_scc1 Lebd_28
  s_cbranch_vccz Lebd_28
  s_sleep 4
  s_branch Leb_27
Lebd_28:
  s_mul_i32 s4, s5, 0x9e3779b1
  s_add_u32 s4, s4, 0x85ebca6b
  v_mov_b32 v31, s4
  s_mov_b64 exec, 1
  buffer_store_dword v31, v30, s[48:51], 0 offen sc1
  s_mov_b64 exec, -1
Lnoep_26:
  s_endpgm
Lrole_a:
  s_cmp_lg_u32 s64, 7
  s_cbranch_scc1 La_go
  s_mov_b32 s63, 0
  s_waitcnt lgkmcnt(0)
  s_mov_b32 s48, s38
  s_and_b32 s49, s39, 0xffff
  s_mov_b32 s50, 268435456
  s_mov_b32 s51, 0x20000
  s_cmp_eq_u32 s3, 8
  s_cbranch_scc1 Ls_ld
  s_cmp_gt_u32 s3, 8
  s_cbranch_scc1 Lexit
  s_barrier
  v_mov_b32 v2, 163832
  ds_read_b32 v3, v2
  s_sub_u32 s70, s65, 16
  s_lshl_b32 s70, s70, 3
  s_add_u32 s70, s70, s3
  s_lshr_b32 s67, s70, 4
  s_and_b32 s66, s70, 15
  s_waitcnt lgkmcnt(0)
  v_readfirstlane_b32 s4, v3
  s_nop 3
  s_lshr_b32 s70, s66, 3
  s_lshl_b32 s71, s67, 1
  s_add_u32 s70, s70, s71
  s_lshl_b32 s70, s70, 16
  s_and_b32 s71, s66, 7
  s_lshl_b32 s71, s71, 9
  s_add_u32 s70, s70, s71
  s_add_u32 s72, s70, 1048576
  v_and_b32 v10, 31, v1
  v_lshlrev_b32 v10, 4, v10
  v_lshrrev_b32 v11, 5, v1
  v_lshl_add_u32 v11, v11, 12, v10
  v_lshlrev_b32 v12, 12, v1
  s_mov_b32 s75, 0x00003f80
  s_mov_b32 s76, 0x3f800000
  s_mov_b32 s73, 0
  s_lshl_b32 s77, s67, 13
  s_lshl_b32 s70, s66, 9
  s_add_u32 s77, s77, s70
  s_add_u32 s77, s77, 524288
  s_barrier
Lred_29:
  s_mov_b32 s70, s72
  buffer_load_dwordx4 v[32:35], v11, s[48:51], s70 offen sc1
  s_add_u32 s70, s70, 8192
  buffer_load_dwordx4 v[36:39], v11, s[48:51], s70 offen sc1
  s_add_u32 s70, s70, 8192
  buffer_load_dwordx4 v[40:43], v11, s[48:51], s70 offen sc1
  s_add_u32 s70, s70, 8192
  buffer_load_dwordx4 v[44:47], v11, s[48:51], s70 offen sc1
  s_add_u32 s70, s70, 8192
  buffer_load_dwordx4 v[48:51], v11, s[48:51], s70 offen sc1
  s_add_u32 s70, s70, 8192
  buffer_load_dwordx4 v[52:55], v11, s[48:51], s70 offen sc1
  s_add_u32 s70, s70, 8192
  buffer_load_dwordx4 v[56:59], v11, s[48:51], s70 offen sc1
  s_add_u32 s70, s70, 8192
  buffer_load_dwordx4 v[60:63], v11, s[48:51], s70 offen sc1
  v_mov_b32 v16, 0
  v_mov_b32 v17, 0
  v_mov_b32 v18, 0
  v_mov_b32 v19, 0
  v_mov_b32 v20, 0
  v_mov_b32 v21, 0
  v_mov_b32 v22, 0
  v_mov_b32 v23, 0
  s_waitcnt vmcnt(7)
  v_dot2_f32_bf16 v16, v32, s75, v16
  v_dot2_f32_bf16 v17, v32, s76, v17
  v_dot2_f32_bf16 v18, v33, s75, v18
  v_dot2_f32_bf16 v19, v33, s76, v19
  v_dot2_f32_bf16 v20, v34, s75, v20
  v_dot2_f32_bf16 v21, v34, s76, v21
  v_dot2_f32_bf16 v22, v35, s75, v22
  v_dot2_f32_bf16 v23, v35, s76, v23
  s_waitcnt vmcnt(6)
  v_dot2_f32_bf16 v16, v36, s75, v16
  v_dot2_f32_bf16 v17, v36, s76, v17
  v_dot2_f32_bf16 v18, v37, s75, v18
  v_dot2_f32_bf16 v19, v37, s76, v19
  v_dot2_f32_bf16 v20, v38, s75, v20
  v_dot2_f32_bf16 v21, v38, s76, v21
  v_dot2_f32_bf16 v22, v39, s75, v22
  v_dot2_f32_bf16 v23, v39, s76, v23
  s_waitcnt vmcnt(5)
  v_dot2_f32_bf16 v16, v40, s75, v16
  v_dot2_f32_bf16 v17, v40, s76, v17
  v_dot2_f32_bf16 v18, v41, s75, v18
  v_dot2_f32_bf16 v19, v41, s76, v19
  v_dot2_f32_bf16 v20, v42, s75, v20
  v_dot2_f32_bf16 v21, v42, s76, v21
  v_dot2_f32_bf16 v22, v43, s75, v22
  v_dot2_f32_bf16 v23, v43, s76, v23
  s_waitcnt vmcnt(4)
  v_dot2_f32_bf16 v16, v44, s75, v16
  v_dot2_f32_bf16 v17, v44, s76, v17
  v_dot2_f32_bf16 v18, v45, s75, v18
  v_dot2_f32_bf16 v19, v45, s76, v19
  v_dot2_f32_bf16 v20, v46, s75, v20
  v_dot2_f32_bf16 v21, v46, s76, v21
  v_dot2_f32_bf16 v22, v47, s75, v22
  v_dot2_f32_bf16 v23, v47, s76, v23
  s_waitcnt vmcnt(3)
  v_dot2_f32_bf16 v16, v48, s75, v16
  v_dot2_f32_bf16 v17, v48, s76, v17
  v_dot2_f32_bf16 v18, v49, s75, v18
  v_dot2_f32_bf16 v19, v49, s76, v19
  v_dot2_f32_bf16 v20, v50, s75, v20
  v_dot2_f32_bf16 v21, v50, s76, v21
  v_dot2_f32_bf16 v22, v51, s75, v22
  v_dot2_f32_bf16 v23, v51, s76, v23
  s_waitcnt vmcnt(2)
  v_dot2_f32_bf16 v16, v52, s75, v16
  v_dot2_f32_bf16 v17, v52, s76, v17
  v_dot2_f32_bf16 v18, v53, s75, v18
  v_dot2_f32_bf16 v19, v53, s76, v19
  v_dot2_f32_bf16 v20, v54, s75, v20
  v_dot2_f32_bf16 v21, v54, s76, v21
  v_dot2_f32_bf16 v22, v55, s75, v22
  v_dot2_f32_bf16 v23, v55, s76, v23
  s_waitcnt vmcnt(1)
  v_dot2_f32_bf16 v16, v56, s75, v16
  v_dot2_f32_bf16 v17, v56, s76, v17
  v_dot2_f32_bf16 v18, v57, s75, v18
  v_dot2_f32_bf16 v19, v57, s76, v19
  v_dot2_f32_bf16 v20, v58, s75, v20
  v_dot2_f32_bf16 v21, v58, s76, v21
  v_dot2_f32_bf16 v22, v59, s75, v22
  v_dot2_f32_bf16 v23, v59, s76, v23
  s_waitcnt vmcnt(0)
  v_dot2_f32_bf16 v16, v60, s75, v16
  v_dot2_f32_bf16 v17, v60, s76, v17
  v_dot2_f32_bf16 v18, v61, s75, v18
  v_dot2_f32_bf16 v19, v61, s76, v19
  v_dot2_f32_bf16 v20, v62, s75, v20
  v_dot2_f32_bf16 v21, v62, s76, v21
  v_dot2_f32_bf16 v22, v63, s75, v22
  v_dot2_f32_bf16 v23, v63, s76, v23
  s_nop 2
  v_mov_b32 v24, v16
  v_mov_b32 v25, v17
  v_mov_b32 v26, v18
  v_mov_b32 v27, v19
  v_mov_b32 v28, v20
  v_mov_b32 v29, v21
  v_mov_b32 v30, v22
  v_mov_b32 v31, v23
  s_nop 1
  v_permlane32_swap_b32 v16, v24
  v_permlane32_swap_b32 v17, v25
  v_permlane32_swap_b32 v18, v26
  v_permlane32_swap_b32 v19, v27
  v_permlane32_swap_b32 v20, v28
  v_permlane32_swap_b32 v21, v29
  v_permlane32_swap_b32 v22, v30
  v_permlane32_swap_b32 v23, v31
  s_nop 0
  v_add_f32 v16, v16, v24
  v_add_f32 v17, v17, v25
  v_add_f32 v18, v18, v26
  v_add_f32 v19, v19, v27
  v_add_f32 v20, v20, v28
  v_add_f32 v21, v21, v29
  v_add_f32 v22, v22, v30
  v_add_f32 v23, v23, v31
  v_pk_add_f32 v[24:25], v[16:17], v[18:19]
  v_pk_add_f32 v[26:27], v[20:21], v[22:23]
  v_pk_add_f32 v[24:25], v[24:25], v[26:27]
  v_add_f32 v24, v24, v25
  s_add_u32 s73, s73, 1
  v_cmp_u_f32 vcc, v24, v24
  s_cmp_gt_u32 s73, 25000
  s_cbranch_scc1 Lredd_30
  s_cbranch_vccz Lredd_30
  s_sleep 2
  s_branch Lred_29
Lredd_30:
  v_cvt_pk_bf16_f32 v24, v16, v17
  v_cvt_pk_bf16_f32 v25, v18, v19
  v_cvt_pk_bf16_f32 v26, v20, v21
  v_cvt_pk_bf16_f32 v27, v22, v23
  s_mov_b32 exec_hi, 0
  buffer_store_dwordx4 v[24:27], v10, s[48:51], s77 offen sc1
  s_mov_b32 exec_hi, -1
  s_cmp_eq_u32 s69, 7
  s_cbranch_scc1 Lexit
  s_cmp_ge_u32 s3, 4
  s_cbranch_scc1 Lexit
  s_barrier
  s_branch Lfinal
Ls_ld:
  s_mov_b32 s52, s32
  s_and_b32 s53, s33, 0xffff
  s_mov_b32 s54, 401408
  s_mov_b32 s55, 0x20000
  s_load_dword s5, s[38:39], 0
  s_waitcnt lgkmcnt(0)
  s_mul_i32 s4, s5, 0x9e3779b1
  s_add_u32 s4, s4, 0x85ebca6b
  v_mov_b32 v2, 163832
  v_mov_b32 v3, s4
  ds_write_b32 v2, v3
  s_waitcnt lgkmcnt(0)
  s_barrier
  s_waitcnt lgkmcnt(0)
  v_mov_b32 v22, 0
  v_mov_b32 v23, 1
  s_mov_b64 exec, 1
  global_atomic_add v22, v23, s[36:37] sc1
  s_mov_b64 exec, -1
  s_sub_u32 s70, s65, 16
  s_lshl_b32 s70, s70, 3
  s_lshr_b32 s67, s70, 4
  s_and_b32 s66, s70, 15
  s_cmp_eq_u32 s69, 7
  s_cbranch_scc1 Lsc7_31
  s_mul_i32 s70, s65, 98
  v_add_u32 v10, s70, v1
  v_lshlrev_b32 v10, 7, v10
  buffer_load_dword v20, v10, s[52:55], 0 offen
  v_min_u32 v11, 33, v1
  s_add_u32 s70, s70, 64
  v_add_u32 v11, s70, v11
  v_lshlrev_b32 v11, 7, v11
  buffer_load_dword v21, v11, s[52:55], 0 offen
  v_lshrrev_b32 v10, 3, v1
  v_and_b32 v11, 7, v1
  v_lshrrev_b32 v12, 1, v11
  v_and_b32 v11, 1, v11
  v_lshlrev_b32 v11, 4, v11
  v_lshrrev_b32 v13, 1, v10
  v_and_b32 v13, 1, v13
  v_xor_b32 v12, v12, v13
  v_mul_u32_u24 v10, 896, v10
  s_lshl_b32 s70, s69, 7
  v_add3_u32 v10, v10, v11, s70
  v_lshlrev_b32 v13, 5, v12
  v_add_u32 v16, v10, v13
  v_xor_b32 v12, 2, v12
  v_lshlrev_b32 v13, 5, v12
  v_add_u32 v17, v10, v13
  v_lshlrev_b32 v24, 3, v1
  v_add_u32 v24, s63, v24
  v_add_u32 v24, 57344, v24
  v_mov_b32 v26, 0
  v_mov_b32 v27, 0
  ds_write_b64 v24, v[26:27]
  s_mov_b32 s73, 0
  s_mov_b32 s70, 0
  s_mov_b32 m0, s63
Lwo_32:
  s_add_u32 s71, s70, 7168
  buffer_load_dwordx4 v16, s[52:55], s70 offen lds
  s_add_u32 m0, m0, 1024
  s_add_u32 s72, s70, 14336
  buffer_load_dwordx4 v16, s[52:55], s71 offen lds
  s_add_u32 m0, m0, 1024
  s_add_u32 s71, s70, 21504
  buffer_load_dwordx4 v17, s[52:55], s72 offen lds
  s_add_u32 m0, m0, 1024
  s_add_u32 s70, s70, 25088
  s_mov_b32 exec_hi, 0
  buffer_load_dwordx4 v17, s[52:55], s71 offen lds
  s_mov_b32 exec_hi, -1
  s_add_u32 m0, m0, 512
  s_add_u32 s73, s73, 1
  s_cmp_lt_u32 s73, 16
  s_cbranch_scc1 Lwo_32
Lsc7_31:
  v_and_b32 v10, 15, v1
  s_lshl_b32 s70, s67, 4
  v_add_u32 v11, s70, v10
  v_lshlrev_b32 v11, 7, v11
  v_add_u32 v15, 69632, v11
  s_mov_b64 exec, 0xffff
  s_mov_b32 s6, 0
Lpoll_33:
  buffer_load_dword v14, v15, s[48:51], 0 offen sc1
  s_add_u32 s6, s6, 1
  s_waitcnt vmcnt(0)
  v_cmp_ne_u32 vcc, s4, v14
  s_cmp_gt_u32 s6, 100000
  s_cbranch_scc1 Lpdone_34
  s_cbranch_vccz Lpdone_34
  s_mov_b64 exec, vcc
  s_sleep 24
  s_branch Lpoll_33
Lpdone_34:
  s_mov_b64 exec, -1
  s_lshr_b32 s70, s66, 3
  s_lshl_b32 s71, s67, 1
  s_add_u32 s70, s70, s71
  s_lshl_b32 s70, s70, 16
  s_and_b32 s71, s66, 7
  s_lshl_b32 s71, s71, 9
  s_add_u32 s70, s70, s71
  s_add_u32 s72, s70, 1048576
  v_lshlrev_b32 v12, 12, v1
  s_mov_b64 exec, 0xffff
  s_mov_b32 s6, 0
Lsp_35:
  buffer_load_dword v13, v12, s[48:51], s72 offen sc1
  s_add_u32 s6, s6, 1
  s_waitcnt vmcnt(0)
  v_cmp_eq_u32 vcc, -1, v13
  s_cmp_gt_u32 s6, 100000
  s_cbranch_scc1 Lsdone_36
  s_cbranch_vccz Lsdone_36
  s_cmp_lg_u32 vcc_lo, 65535
  s_cbranch_scc1 Lsf_37
  s_sleep 24
Lsf_37:
  s_mov_b64 exec, vcc
  s_sleep 3
  s_branch Lsp_35
Lsdone_36:
  s_mov_b64 exec, -1
  s_barrier
  s_cmp_eq_u32 s69, 7
  s_cbranch_scc1 Lexit
  v_and_b32 v10, 7, v1
  v_lshlrev_b32 v12, 4, v10
  s_lshr_b32 s71, s68, 1
  v_add_u32 v12, s71, v12
  v_lshlrev_b32 v12, 7, v12
  v_add_u32 v15, 69632, v12
  s_mov_b64 exec, 0xff
  s_mov_b32 s6, 0
Lpoll_38:
  buffer_load_dword v14, v15, s[48:51], 0 offen sc1
  s_add_u32 s6, s6, 1
  s_waitcnt vmcnt(0)
  v_cmp_ne_u32 vcc, s4, v14
  s_cmp_gt_u32 s6, 100000
  s_cbranch_scc1 Lpdone_39
  s_cbranch_vccz Lpdone_39
  s_mov_b64 exec, vcc
  s_sleep 16
  s_branch Lpoll_38
Lpdone_39:
  s_mov_b64 exec, -1
  s_waitcnt vmcnt(0) lgkmcnt(0)
  s_barrier
  s_barrier
  s_endpgm
La_go:
  s_sub_u32 s70, s65, 16
  s_lshl_b32 s70, s70, 2
  s_lshl_b32 s66, s64, 6
  s_add_u32 s66, s66, s70
  s_mov_b32 s63, 104448
  s_cmp_ge_u32 s3, 8
  s_cbranch_scc1 La_u
  s_lshr_b32 s67, s3, 1
  s_and_b32 s60, s3, 1
  s_add_u32 s70, s66, s67
  s_lshl_b32 s72, s70, 1
  s_lshl_b32 s70, s70, 9
  s_lshl_b32 s71, s60, 8
  s_add_u32 s70, s70, s71
  v_lshlrev_b32 v2, 1, v1
  v_add_u32 v2, s70, v2
  s_getpc_b64 s[76:77]
La_pc:
  s_add_u32 s76, s76, Ltab_la-La_pc
  s_addc_u32 s77, s77, 0
  s_and_b32 s71, s72, 0xfffffffc
  s_mov_b32 s78, 0x3fb8aa3b
  s_waitcnt lgkmcnt(0)
  s_mov_b32 s48, s38
  s_and_b32 s49, s39, 0xffff
  s_mov_b32 s50, 268435456
  s_mov_b32 s51, 0x20000
  s_mov_b32 s40, s10
  s_and_b32 s41, s11, 0xffff
  s_mov_b32 s42, 229376
  s_mov_b32 s43, 0x20000
  buffer_load_ushort v16, v2, s[40:43], 0 offen
  buffer_load_ushort v17, v2, s[40:43], 0 offen offset:128
  s_mov_b32 s44, s12
  s_and_b32 s45, s13, 0xffff
  s_mov_b32 s46, 229376
  s_mov_b32 s47, 0x20000
  buffer_load_ushort v18, v2, s[44:47], 0 offen
  buffer_load_ushort v19, v2, s[44:47], 0 offen offset:128
  s_mov_b32 s40, s14
  s_and_b32 s41, s15, 0xffff
  s_mov_b32 s42, 229376
  s_mov_b32 s43, 0x20000
  buffer_load_ushort v20, v2, s[40:43], 0 offen
  buffer_load_ushort v21, v2, s[40:43], 0 offen offset:128
  s_mov_b32 s44, s16
  s_and_b32 s45, s17, 0xffff
  s_mov_b32 s46, 229376
  s_mov_b32 s47, 0x20000
  buffer_load_ushort v22, v2, s[44:47], 0 offen
  buffer_load_ushort v23, v2, s[44:47], 0 offen offset:128
  s_mov_b32 s40, s18
  s_and_b32 s41, s19, 0xffff
  s_mov_b32 s42, 229376
  s_mov_b32 s43, 0x20000
  buffer_load_ushort v24, v2, s[40:43], 0 offen
  buffer_load_ushort v25, v2, s[40:43], 0 offen offset:128
  s_mov_b32 s44, s20
  s_and_b32 s45, s21, 0xffff
  s_mov_b32 s46, 229376
  s_mov_b32 s47, 0x20000
  buffer_load_ushort v26, v2, s[44:47], 0 offen
  buffer_load_ushort v27, v2, s[44:47], 0 offen offset:128
  s_mov_b32 s52, s76
  s_and_b32 s53, s77, 0xffff
  s_mov_b32 s54, 6400
  s_mov_b32 s55, 0x20000
  s_add_u32 s6, s22, s71
  s_addc_u32 s7, s23, 0
  s_load_dword s61, s[6:7], 0
  s_and_b32 s72, s72, 2
  s_lshl_b32 s72, s72, 3
  s_mul_i32 s77, s3, 14592
  v_lshlrev_b32 v6, 2, v1
  v_add_u32 v6, s77, v6
  v_and_b32 v2, 15, v1
  v_lshrrev_b32 v3, 4, v1
  v_lshlrev_b32 v3, 4, v3
  v_add_u32 v3, s77, v3
  v_min_u32 v4, 12, v2
  v_mul_u32_u24 v4, 272, v4
  v_add_u32 v7, v4, v3
  v_lshrrev_b32 v4, 1, v2
  v_subrev_u32 v5, 4, v2
  v_cmp_lt_u32 vcc, 7, v2
  s_nop 1
  v_cndmask_b32 v4, v4, v5, vcc
  v_min_u32 v4, 7, v4
  v_add_u32 v4, 13, v4
  v_mul_u32_u24 v4, 272, v4
  v_add_u32 v8, v4, v3
  v_add_u32 v4, 21, v2
  v_mul_u32_u24 v4, 272, v4
  v_add_u32 v9, v4, v3
  v_add_u32 v10, 4352, v9
  s_waitcnt lgkmcnt(0)
  s_lshr_b32 s61, s61, s72
  s_lshl_b32 s61, s61, 16
  v_mov_b32 v33, s61
  v_mul_f32 v34, s78, v33
  v_fma_f32 v35, v33, s78, -v34
  v_mov_b32 v36, 0x32a57060
  v_fmac_f32 v35, v33, v36
  v_exp_f32 v34, v34
  v_mul_f32 v35, 0x3f317218, v35
  s_nop 0
  v_fma_f32 v34, v34, v35, v34
  v_cvt_pk_bf16_f32 v34, v34, v34
  v_and_b32 v32, 0xffff0000, v34
  v_mov_b32 v96, 0
  v_mov_b32 v97, 0
  v_mov_b32 v98, 0
  v_mov_b32 v99, 0
  v_mov_b32 v100, 0
  v_mov_b32 v101, 0
  v_mov_b32 v102, 0
  v_mov_b32 v103, 0
  v_mov_b32 v104, 0
  v_mov_b32 v105, 0
  v_mov_b32 v106, 0
  v_mov_b32 v107, 0
  v_mov_b32 v108, 0
  v_mov_b32 v109, 0
  v_mov_b32 v110, 0
  v_mov_b32 v111, 0
  s_waitcnt vmcnt(0)
  v_lshlrev_b32 v4, 5, v1
  s_lshl_b32 s70, s60, 11
  v_add_u32 v5, s70, v4
  buffer_load_dwordx4 v[112:115], v4, s[52:55], 0 offen offset:256
  buffer_load_dwordx4 v[116:119], v4, s[52:55], 0 offen offset:272
  buffer_load_dwordx4 v[120:123], v5, s[52:55], 0 offen offset:2304
  buffer_load_dwordx4 v[124:127], v5, s[52:55], 0 offen offset:2320
  v_lshlrev_b32 v16, 16, v16
  v_lshlrev_b32 v17, 16, v17
  v_lshlrev_b32 v18, 16, v18
  v_lshlrev_b32 v19, 16, v19
  v_lshlrev_b32 v20, 16, v20
  v_lshlrev_b32 v21, 16, v21
  v_lshlrev_b32 v22, 16, v22
  v_lshlrev_b32 v23, 16, v23
  v_lshlrev_b32 v24, 16, v24
  v_lshlrev_b32 v25, 16, v25
  v_lshlrev_b32 v26, 16, v26
  v_lshlrev_b32 v27, 16, v27
  s_mov_b32 s73, 0
Lkg_40:
  v_mul_f32 v54, v32, v16
  v_mul_f32 v62, s78, v54
  v_mul_f32 v54, v32, v18
  v_mul_f32 v63, 0.15915494, v54
  v_mul_f32 v54, v32, v20
  v_mul_f32 v55, v32, v22
  v_mul_f32 v56, v26, v55
  v_fma_f32 v34, v24, v54, -v56
  v_mul_f32 v56, v26, v54
  v_fma_f32 v35, v24, v55, v56
  v_fract_f32 v55, v63
  v_exp_f32 v54, v62
  v_cos_f32 v36, v55
  v_sin_f32 v37, v55
  s_nop 0
  v_pk_mul_f32 v[36:37], v[36:37], v[54:55] op_sel_hi:[1,0]
  v_mul_f32 v54, 0x41000000, v62
  v_mul_f32 v55, 0x41000000, v63
  v_fract_f32 v55, v55
  v_exp_f32 v54, v54
  v_cos_f32 v38, v55
  v_sin_f32 v39, v55
  s_nop 0
  v_pk_mul_f32 v[38:39], v[38:39], v[54:55] op_sel_hi:[1,0]
  v_mul_f32 v54, 0x43000000, v62
  v_mul_f32 v55, 0x43000000, v63
  v_fract_f32 v55, v55
  v_exp_f32 v54, v54
  v_cos_f32 v40, v55
  v_sin_f32 v41, v55
  s_nop 0
  v_pk_mul_f32 v[40:41], v[40:41], v[54:55] op_sel_hi:[1,0]
  v_mov_b32 v58, 0x00003f80
  ds_write_b32 v6, v58 offset:5712
  v_cvt_pk_bf16_f32 v59, v38, v39
  ds_write_b32 v6, v59 offset:5984
  v_cvt_pk_bf16_f32 v60, v40, v41
  ds_write_b32 v6, v60 offset:10064
  v_pk_mul_f32 v[54:55], v[40:41], v[38:39] op_sel_hi:[1,0]
  v_pk_fma_f32 v[50:51], v[40:41], v[38:39], v[54:55] op_sel:[1,1,0] op_sel_hi:[0,1,1] neg_lo:[0,1,0]
  v_pk_mul_f32 v[54:55], v[38:39], v[38:39] op_sel_hi:[1,0]
  v_pk_fma_f32 v[48:49], v[38:39], v[38:39], v[54:55] op_sel:[1,1,0] op_sel_hi:[0,1,1] neg_lo:[0,1,0]
  v_cvt_pk_bf16_f32 v61, v50, v51
  ds_write_b32 v6, v61 offset:10336
  v_cvt_pk_bf16_f32 v58, v48, v49
  ds_write_b32 v6, v58 offset:6256
  v_pk_mul_f32 v[54:55], v[48:49], v[38:39] op_sel_hi:[1,0]
  v_pk_fma_f32 v[52:53], v[48:49], v[38:39], v[54:55] op_sel:[1,1,0] op_sel_hi:[0,1,1] neg_lo:[0,1,0]
  v_pk_mul_f32 v[54:55], v[50:51], v[38:39] op_sel_hi:[1,0]
  v_pk_fma_f32 v[56:57], v[50:51], v[38:39], v[54:55] op_sel:[1,1,0] op_sel_hi:[0,1,1] neg_lo:[0,1,0]
  v_cvt_pk_bf16_f32 v59, v52, v53
  ds_write_b32 v6, v59 offset:6528
  v_cvt_pk_bf16_f32 v60, v56, v57
  ds_write_b32 v6, v60 offset:10608
  v_pk_mul_f32 v[54:55], v[52:53], v[38:39] op_sel_hi:[1,0]
  v_pk_fma_f32 v[48:49], v[52:53], v[38:39], v[54:55] op_sel:[1,1,0] op_sel_hi:[0,1,1] neg_lo:[0,1,0]
  v_pk_mul_f32 v[54:55], v[56:57], v[38:39] op_sel_hi:[1,0]
  v_pk_fma_f32 v[50:51], v[56:57], v[38:39], v[54:55] op_sel:[1,1,0] op_sel_hi:[0,1,1] neg_lo:[0,1,0]
  v_cvt_pk_bf16_f32 v61, v48, v49
  ds_write_b32 v6, v61 offset:6800
  v_cvt_pk_bf16_f32 v58, v50, v51
  ds_write_b32 v6, v58 offset:10880
  v_pk_mul_f32 v[54:55], v[48:49], v[38:39] op_sel_hi:[1,0]
  v_pk_fma_f32 v[52:53], v[48:49], v[38:39], v[54:55] op_sel:[1,1,0] op_sel_hi:[0,1,1] neg_lo:[0,1,0]
  v_pk_mul_f32 v[54:55], v[50:51], v[38:39] op_sel_hi:[1,0]
  v_pk_fma_f32 v[56:57], v[50:51], v[38:39], v[54:55] op_sel:[1,1,0] op_sel_hi:[0,1,1] neg_lo:[0,1,0]
  v_cvt_pk_bf16_f32 v59, v52, v53
  ds_write_b32 v6, v59 offset:7072
  v_cvt_pk_bf16_f32 v60, v56, v57
  ds_write_b32 v6, v60 offset:11152
  v_pk_mul_f32 v[54:55], v[52:53], v[38:39] op_sel_hi:[1,0]
  v_pk_fma_f32 v[48:49], v[52:53], v[38:39], v[54:55] op_sel:[1,1,0] op_sel_hi:[0,1,1] neg_lo:[0,1,0]
  v_pk_mul_f32 v[54:55], v[56:57], v[38:39] op_sel_hi:[1,0]
  v_pk_fma_f32 v[50:51], v[56:57], v[38:39], v[54:55] op_sel:[1,1,0] op_sel_hi:[0,1,1] neg_lo:[0,1,0]
  v_cvt_pk_bf16_f32 v61, v48, v49
  ds_write_b32 v6, v61 offset:7344
  v_cvt_pk_bf16_f32 v58, v50, v51
  ds_write_b32 v6, v58 offset:11424
  v_pk_mul_f32 v[54:55], v[48:49], v[38:39] op_sel_hi:[1,0]
  v_pk_fma_f32 v[52:53], v[48:49], v[38:39], v[54:55] op_sel:[1,1,0] op_sel_hi:[0,1,1] neg_lo:[0,1,0]
  v_pk_mul_f32 v[54:55], v[50:51], v[38:39] op_sel_hi:[1,0]
  v_pk_fma_f32 v[56:57], v[50:51], v[38:39], v[54:55] op_sel:[1,1,0] op_sel_hi:[0,1,1] neg_lo:[0,1,0]
  v_cvt_pk_bf16_f32 v59, v52, v53
  ds_write_b32 v6, v59 offset:7616
  v_cvt_pk_bf16_f32 v60, v56, v57
  ds_write_b32 v6, v60 offset:11696
  v_pk_mul_f32 v[54:55], v[52:53], v[38:39] op_sel_hi:[1,0]
  v_pk_fma_f32 v[48:49], v[52:53], v[38:39], v[54:55] op_sel:[1,1,0] op_sel_hi:[0,1,1] neg_lo:[0,1,0]
  v_pk_mul_f32 v[54:55], v[56:57], v[38:39] op_sel_hi:[1,0]
  v_pk_fma_f32 v[50:51], v[56:57], v[38:39], v[54:55] op_sel:[1,1,0] op_sel_hi:[0,1,1] neg_lo:[0,1,0]
  v_cvt_pk_bf16_f32 v61, v48, v49
  ds_write_b32 v6, v61 offset:7888
  v_cvt_pk_bf16_f32 v58, v50, v51
  ds_write_b32 v6, v58 offset:11968
  v_pk_mul_f32 v[54:55], v[48:49], v[38:39] op_sel_hi:[1,0]
  v_pk_fma_f32 v[52:53], v[48:49], v[38:39], v[54:55] op_sel:[1,1,0] op_sel_hi:[0,1,1] neg_lo:[0,1,0]
  v_pk_mul_f32 v[54:55], v[50:51], v[38:39] op_sel_hi:[1,0]
  v_pk_fma_f32 v[56:57], v[50:51], v[38:39], v[54:55] op_sel:[1,1,0] op_sel_hi:[0,1,1] neg_lo:[0,1,0]
  v_cvt_pk_bf16_f32 v59, v52, v53
  ds_write_b32 v6, v59 offset:8160
  v_cvt_pk_bf16_f32 v60, v56, v57
  ds_write_b32 v6, v60 offset:12240
  v_pk_mul_f32 v[54:55], v[52:53], v[38:39] op_sel_hi:[1,0]
  v_pk_fma_f32 v[48:49], v[52:53], v[38:39], v[54:55] op_sel:[1,1,0] op_sel_hi:[0,1,1] neg_lo:[0,1,0]
  v_pk_mul_f32 v[54:55], v[56:57], v[38:39] op_sel_hi:[1,0]
  v_pk_fma_f32 v[50:51], v[56:57], v[38:39], v[54:55] op_sel:[1,1,0] op_sel_hi:[0,1,1] neg_lo:[0,1,0]
  v_cvt_pk_bf16_f32 v61, v48, v49
  ds_write_b32 v6, v61 offset:8432
  v_cvt_pk_bf16_f32 v58, v50, v51
  ds_write_b32 v6, v58 offset:12512
  v_pk_mul_f32 v[54:55], v[48:49], v[38:39] op_sel_hi:[1,0]
  v_pk_fma_f32 v[52:53], v[48:49], v[38:39], v[54:55] op_sel:[1,1,0] op_sel_hi:[0,1,1] neg_lo:[0,1,0]
  v_pk_mul_f32 v[54:55], v[50:51], v[38:39] op_sel_hi:[1,0]
  v_pk_fma_f32 v[56:57], v[50:51], v[38:39], v[54:55] op_sel:[1,1,0] op_sel_hi:[0,1,1] neg_lo:[0,1,0]
  v_cvt_pk_bf16_f32 v59, v52, v53
  ds_write_b32 v6, v59 offset:8704
  v_cvt_pk_bf16_f32 v60, v56, v57
  ds_write_b32 v6, v60 offset:12784
  v_pk_mul_f32 v[54:55], v[52:53], v[38:39] op_sel_hi:[1,0]
  v_pk_fma_f32 v[48:49], v[52:53], v[38:39], v[54:55] op_sel:[1,1,0] op_sel_hi:[0,1,1] neg_lo:[0,1,0]
  v_pk_mul_f32 v[54:55], v[56:57], v[38:39] op_sel_hi:[1,0]
  v_pk_fma_f32 v[50:51], v[56:57], v[38:39], v[54:55] op_sel:[1,1,0] op_sel_hi:[0,1,1] neg_lo:[0,1,0]
  v_cvt_pk_bf16_f32 v61, v48, v49
  ds_write_b32 v6, v61 offset:8976
  v_cvt_pk_bf16_f32 v58, v50, v51
  ds_write_b32 v6, v58 offset:13056
  v_pk_mul_f32 v[54:55], v[48:49], v[38:39] op_sel_hi:[1,0]
  v_pk_fma_f32 v[52:53], v[48:49], v[38:39], v[54:55] op_sel:[1,1,0] op_sel_hi:[0,1,1] neg_lo:[0,1,0]
  v_pk_mul_f32 v[54:55], v[50:51], v[38:39] op_sel_hi:[1,0]
  v_pk_fma_f32 v[56:57], v[50:51], v[38:39], v[54:55] op_sel:[1,1,0] op_sel_hi:[0,1,1] neg_lo:[0,1,0]
  v_cvt_pk_bf16_f32 v59, v52, v53
  ds_write_b32 v6, v59 offset:9248
  v_cvt_pk_bf16_f32 v60, v56, v57
  ds_write_b32 v6, v60 offset:13328
  v_pk_mul_f32 v[54:55], v[52:53], v[38:39] op_sel_hi:[1,0]
  v_pk_fma_f32 v[48:49], v[52:53], v[38:39], v[54:55] op_sel:[1,1,0] op_sel_hi:[0,1,1] neg_lo:[0,1,0]
  v_pk_mul_f32 v[54:55], v[56:57], v[38:39] op_sel_hi:[1,0]
  v_pk_fma_f32 v[50:51], v[56:57], v[38:39], v[54:55] op_sel:[1,1,0] op_sel_hi:[0,1,1] neg_lo:[0,1,0]
  v_cvt_pk_bf16_f32 v61, v48, v49
  ds_write_b32 v6, v61 offset:9520
  v_cvt_pk_bf16_f32 v58, v50, v51
  ds_write_b32 v6, v58 offset:13600
  v_pk_mul_f32 v[54:55], v[48:49], v[38:39] op_sel_hi:[1,0]
  v_pk_fma_f32 v[52:53], v[48:49], v[38:39], v[54:55] op_sel:[1,1,0] op_sel_hi:[0,1,1] neg_lo:[0,1,0]
  v_pk_mul_f32 v[54:55], v[50:51], v[38:39] op_sel_hi:[1,0]
  v_pk_fma_f32 v[56:57], v[50:51], v[38:39], v[54:55] op_sel:[1,1,0] op_sel_hi:[0,1,1] neg_lo:[0,1,0]
  v_cvt_pk_bf16_f32 v59, v52, v53
  ds_write_b32 v6, v59 offset:9792
  v_cvt_pk_bf16_f32 v60, v56, v57
  ds_write_b32 v6, v60 offset:13872
  v_pk_mul_f32 v[54:55], v[56:57], v[38:39] op_sel_hi:[1,0]
  v_pk_fma_f32 v[50:51], v[56:57], v[38:39], v[54:55] op_sel:[1,1,0] op_sel_hi:[0,1,1] neg_lo:[0,1,0]
  v_cvt_pk_bf16_f32 v61, v50, v51
  ds_write_b32 v6, v61 offset:14144
  v_pk_mul_f32 v[54:55], v[40:41], v[40:41] op_sel_hi:[1,0]
  v_pk_fma_f32 v[42:43], v[40:41], v[40:41], v[54:55] op_sel:[1,1,0] op_sel_hi:[0,1,1] neg_lo:[0,1,0]
  v_pk_mul_f32 v[54:55], v[42:43], v[42:43] op_sel_hi:[1,0]
  v_pk_fma_f32 v[44:45], v[42:43], v[42:43], v[54:55] op_sel:[1,1,0] op_sel_hi:[0,1,1] neg_lo:[0,1,0]
  v_pk_mul_f32 v[54:55], v[44:45], v[44:45] op_sel_hi:[1,0]
  v_pk_fma_f32 v[46:47], v[44:45], v[44:45], v[54:55] op_sel:[1,1,0] op_sel_hi:[0,1,1] neg_lo:[0,1,0]
  v_cvt_pk_bf16_f32 v58, v34, -v35
  ds_write_b32 v6, v58 offset:0
  v_pk_mul_f32 v[54:55], v[34:35], v[42:43] op_sel_hi:[1,0]
  v_pk_fma_f32 v[50:51], v[34:35], v[42:43], v[54:55] op_sel:[1,1,0] op_sel_hi:[0,1,1] neg_lo:[0,1,0]
  v_cvt_pk_bf16_f32 v59, v50, -v51
  ds_write_b32 v6, v59 offset:3536
  v_pk_mul_f32 v[54:55], v[34:35], v[36:37] op_sel_hi:[1,0]
  v_pk_fma_f32 v[48:49], v[34:35], v[36:37], v[54:55] op_sel:[1,1,0] op_sel_hi:[0,1,1] neg_lo:[0,1,0]
  v_cvt_pk_bf16_f32 v60, v48, -v49
  ds_write_b32 v6, v60 offset:272
  v_pk_mul_f32 v[54:55], v[48:49], v[36:37] op_sel_hi:[1,0]
  v_pk_fma_f32 v[52:53], v[48:49], v[36:37], v[54:55] op_sel:[1,1,0] op_sel_hi:[0,1,1] neg_lo:[0,1,0]
  v_cvt_pk_bf16_f32 v61, v52, -v53
  ds_write_b32 v6, v61 offset:544
  v_pk_mul_f32 v[54:55], v[52:53], v[42:43] op_sel_hi:[1,0]
  v_pk_fma_f32 v[50:51], v[52:53], v[42:43], v[54:55] op_sel:[1,1,0] op_sel_hi:[0,1,1] neg_lo:[0,1,0]
  v_cvt_pk_bf16_f32 v58, v50, -v51
  ds_write_b32 v6, v58 offset:3808
  v_pk_mul_f32 v[54:55], v[52:53], v[36:37] op_sel_hi:[1,0]
  v_pk_fma_f32 v[48:49], v[52:53], v[36:37], v[54:55] op_sel:[1,1,0] op_sel_hi:[0,1,1] neg_lo:[0,1,0]
  v_cvt_pk_bf16_f32 v59, v48, -v49
  ds_write_b32 v6, v59 offset:816
  v_pk_mul_f32 v[54:55], v[48:49], v[36:37] op_sel_hi:[1,0]
  v_pk_fma_f32 v[52:53], v[48:49], v[36:37], v[54:55] op_sel:[1,1,0] op_sel_hi:[0,1,1] neg_lo:[0,1,0]
  v_cvt_pk_bf16_f32 v60, v52, -v53
  ds_write_b32 v6, v60 offset:1088
  v_pk_mul_f32 v[54:55], v[52:53], v[42:43] op_sel_hi:[1,0]
  v_pk_fma_f32 v[50:51], v[52:53], v[42:43], v[54:55] op_sel:[1,1,0] op_sel_hi:[0,1,1] neg_lo:[0,1,0]
  v_cvt_pk_bf16_f32 v61, v50, -v51
  ds_write_b32 v6, v61 offset:4080
  v_pk_mul_f32 v[54:55], v[52:53], v[36:37] op_sel_hi:[1,0]
  v_pk_fma_f32 v[48:49], v[52:53], v[36:37], v[54:55] op_sel:[1,1,0] op_sel_hi:[0,1,1] neg_lo:[0,1,0]
  v_cvt_pk_bf16_f32 v58, v48, -v49
  ds_write_b32 v6, v58 offset:1360
  v_pk_mul_f32 v[54:55], v[48:49], v[36:37] op_sel_hi:[1,0]
  v_pk_fma_f32 v[52:53], v[48:49], v[36:37], v[54:55] op_sel:[1,1,0] op_sel_hi:[0,1,1] neg_lo:[0,1,0]
  v_cvt_pk_bf16_f32 v59, v52, -v53
  ds_write_b32 v6, v59 offset:1632
  v_pk_mul_f32 v[54:55], v[52:53], v[42:43] op_sel_hi:[1,0]
  v_pk_fma_f32 v[50:51], v[52:53], v[42:43], v[54:55] op_sel:[1,1,0] op_sel_hi:[0,1,1] neg_lo:[0,1,0]
  v_cvt_pk_bf16_f32 v60, v50, -v51
  ds_write_b32 v6, v60 offset:4352
  v_pk_mul_f32 v[54:55], v[52:53], v[36:37] op_sel_hi:[1,0]
  v_pk_fma_f32 v[48:49], v[52:53], v[36:37], v[54:55] op_sel:[1,1,0] op_sel_hi:[0,1,1] neg_lo:[0,1,0]
  v_cvt_pk_bf16_f32 v61, v48, -v49
  ds_write_b32 v6, v61 offset:1904
  v_pk_mul_f32 v[54:55], v[34:35], v[44:45] op_sel_hi:[1,0]
  v_pk_fma_f32 v[48:49], v[34:35], v[44:45], v[54:55] op_sel:[1,1,0] op_sel_hi:[0,1,1] neg_lo:[0,1,0]
  v_cvt_pk_bf16_f32 v58, v48, -v49
  ds_write_b32 v6, v58 offset:2176
  v_pk_mul_f32 v[54:55], v[48:49], v[42:43] op_sel_hi:[1,0]
  v_pk_fma_f32 v[50:51], v[48:49], v[42:43], v[54:55] op_sel:[1,1,0] op_sel_hi:[0,1,1] neg_lo:[0,1,0]
  v_cvt_pk_bf16_f32 v59, v50, -v51
  ds_write_b32 v6, v59 offset:4624
  v_pk_mul_f32 v[54:55], v[36:37], v[36:37] op_sel_hi:[1,0]
  v_pk_fma_f32 v[56:57], v[36:37], v[36:37], v[54:55] op_sel:[1,1,0] op_sel_hi:[0,1,1] neg_lo:[0,1,0]
  v_pk_mul_f32 v[54:55], v[56:57], v[56:57] op_sel_hi:[1,0]
  v_pk_fma_f32 v[52:53], v[56:57], v[56:57], v[54:55] op_sel:[1,1,0] op_sel_hi:[0,1,1] neg_lo:[0,1,0]
  v_pk_mul_f32 v[54:55], v[48:49], v[52:53] op_sel_hi:[1,0]
  v_pk_fma_f32 v[56:57], v[48:49], v[52:53], v[54:55] op_sel:[1,1,0] op_sel_hi:[0,1,1] neg_lo:[0,1,0]
  v_cvt_pk_bf16_f32 v60, v56, -v57
  ds_write_b32 v6, v60 offset:2448
  v_pk_mul_f32 v[54:55], v[56:57], v[42:43] op_sel_hi:[1,0]
  v_pk_fma_f32 v[50:51], v[56:57], v[42:43], v[54:55] op_sel:[1,1,0] op_sel_hi:[0,1,1] neg_lo:[0,1,0]
  v_cvt_pk_bf16_f32 v61, v50, -v51
  ds_write_b32 v6, v61 offset:4896
  v_pk_mul_f32 v[54:55], v[48:49], v[44:45] op_sel_hi:[1,0]
  v_pk_fma_f32 v[56:57], v[48:49], v[44:45], v[54:55] op_sel:[1,1,0] op_sel_hi:[0,1,1] neg_lo:[0,1,0]
  v_cvt_pk_bf16_f32 v58, v56, -v57
  ds_write_b32 v6, v58 offset:2720
  v_pk_mul_f32 v[54:55], v[56:57], v[42:43] op_sel_hi:[1,0]
  v_pk_fma_f32 v[50:51], v[56:57], v[42:43], v[54:55] op_sel:[1,1,0] op_sel_hi:[0,1,1] neg_lo:[0,1,0]
  v_cvt_pk_bf16_f32 v59, v50, -v51
  ds_write_b32 v6, v59 offset:5168
  v_pk_mul_f32 v[54:55], v[56:57], v[44:45] op_sel_hi:[1,0]
  v_pk_fma_f32 v[52:53], v[56:57], v[44:45], v[54:55] op_sel:[1,1,0] op_sel_hi:[0,1,1] neg_lo:[0,1,0]
  v_cvt_pk_bf16_f32 v60, v52, -v53
  ds_write_b32 v6, v60 offset:2992
  v_pk_mul_f32 v[54:55], v[52:53], v[42:43] op_sel_hi:[1,0]
  v_pk_fma_f32 v[50:51], v[52:53], v[42:43], v[54:55] op_sel:[1,1,0] op_sel_hi:[0,1,1] neg_lo:[0,1,0]
  v_cvt_pk_bf16_f32 v61, v50, -v51
  ds_write_b32 v6, v61 offset:5440
  v_pk_mul_f32 v[54:55], v[56:57], v[46:47] op_sel_hi:[1,0]
  v_pk_fma_f32 v[52:53], v[56:57], v[46:47], v[54:55] op_sel:[1,1,0] op_sel_hi:[0,1,1] neg_lo:[0,1,0]
  v_cvt_pk_bf16_f32 v58, v52, -v53
  ds_write_b32 v6, v58 offset:3264
  v_mov_b32 v16, v17
  v_mov_b32 v18, v19
  v_mov_b32 v20, v21
  v_mov_b32 v22, v23
  v_mov_b32 v24, v25
  v_mov_b32 v26, v27
  s_waitcnt lgkmcnt(0)
  ds_read_b128 v[64:67], v7 offset:0
  ds_read_b128 v[68:71], v8 offset:0
  ds_read_b128 v[72:75], v9 offset:0
  ds_read_b128 v[76:79], v10 offset:0
  ds_read_b128 v[80:83], v7 offset:64
  ds_read_b128 v[84:87], v8 offset:64
  ds_read_b128 v[88:91], v9 offset:64
  ds_read_b128 v[92:95], v10 offset:64
  s_waitcnt lgkmcnt(4)
  v_mfma_f32_16x16x32_bf16 v[96:99], v[64:67], v[72:75], v[96:99]
  v_mfma_f32_16x16x32_bf16 v[100:103], v[64:67], v[76:79], v[100:103]
  v_mfma_f32_16x16x32_bf16 v[104:107], v[68:71], v[72:75], v[104:107]
  v_mfma_f32_16x16x32_bf16 v[108:111], v[68:71], v[76:79], v[108:111]
  ds_read_b128 v[64:67], v7 offset:128
  ds_read_b128 v[68:71], v8 offset:128
  ds_read_b128 v[72:75], v9 offset:128
  ds_read_b128 v[76:79], v10 offset:128
  s_waitcnt lgkmcnt(4)
  v_mfma_f32_16x16x32_bf16 v[96:99], v[80:83], v[88:91], v[96:99]
  v_mfma_f32_16x16x32_bf16 v[100:103], v[80:83], v[92:95], v[100:103]
  v_mfma_f32_16x16x32_bf16 v[104:107], v[84:87], v[88:91], v[104:107]
  v_mfma_f32_16x16x32_bf16 v[108:111], v[84:87], v[92:95], v[108:111]
  ds_read_b128 v[80:83], v7 offset:192
  ds_read_b128 v[84:87], v8 offset:192
  ds_read_b128 v[88:91], v9 offset:192
  ds_read_b128 v[92:95], v10 offset:192
  s_waitcnt lgkmcnt(4)
  v_mfma_f32_16x16x32_bf16 v[96:99], v[64:67], v[72:75], v[96:99]
  v_mfma_f32_16x16x32_bf16 v[100:103], v[64:67], v[76:79], v[100:103]
  v_mfma_f32_16x16x32_bf16 v[104:107], v[68:71], v[72:75], v[104:107]
  v_mfma_f32_16x16x32_bf16 v[108:111], v[68:71], v[76:79], v[108:111]
  s_waitcnt lgkmcnt(0)
  v_mfma_f32_16x16x32_bf16 v[96:99], v[80:83], v[88:91], v[96:99]
  v_mfma_f32_16x16x32_bf16 v[100:103], v[80:83], v[92:95], v[100:103]
  v_mfma_f32_16x16x32_bf16 v[104:107], v[84:87], v[88:91], v[104:107]
  v_mfma_f32_16x16x32_bf16 v[108:111], v[84:87], v[92:95], v[108:111]
  s_add_u32 s73, s73, 1
  s_cmp_lt_u32 s73, 2
  s_cbranch_scc1 Lkg_40
  s_waitcnt vmcnt(0)
  v_mov_b32 v4, s77
  v_add_u32_sdwa v48, v4, v112 dst_sel:DWORD dst_unused:UNUSED_PAD src0_sel:DWORD src1_sel:WORD_0
  v_add_u32_sdwa v49, v4, v112 dst_sel:DWORD dst_unused:UNUSED_PAD src0_sel:DWORD src1_sel:WORD_1
  v_add_u32_sdwa v50, v4, v113 dst_sel:DWORD dst_unused:UNUSED_PAD src0_sel:DWORD src1_sel:WORD_0
  v_add_u32_sdwa v51, v4, v113 dst_sel:DWORD dst_unused:UNUSED_PAD src0_sel:DWORD src1_sel:WORD_1
  v_add_u32_sdwa v52, v4, v114 dst_sel:DWORD dst_unused:UNUSED_PAD src0_sel:DWORD src1_sel:WORD_0
  v_add_u32_sdwa v53, v4, v114 dst_sel:DWORD dst_unused:UNUSED_PAD src0_sel:DWORD src1_sel:WORD_1
  v_add_u32_sdwa v54, v4, v115 dst_sel:DWORD dst_unused:UNUSED_PAD src0_sel:DWORD src1_sel:WORD_0
  v_add_u32_sdwa v55, v4, v115 dst_sel:DWORD dst_unused:UNUSED_PAD src0_sel:DWORD src1_sel:WORD_1
  v_add_u32_sdwa v56, v4, v116 dst_sel:DWORD dst_unused:UNUSED_PAD src0_sel:DWORD src1_sel:WORD_0
  v_add_u32_sdwa v57, v4, v116 dst_sel:DWORD dst_unused:UNUSED_PAD src0_sel:DWORD src1_sel:WORD_1
  v_add_u32_sdwa v58, v4, v117 dst_sel:DWORD dst_unused:UNUSED_PAD src0_sel:DWORD src1_sel:WORD_0
  v_add_u32_sdwa v59, v4, v117 dst_sel:DWORD dst_unused:UNUSED_PAD src0_sel:DWORD src1_sel:WORD_1
  v_add_u32_sdwa v60, v4, v118 dst_sel:DWORD dst_unused:UNUSED_PAD src0_sel:DWORD src1_sel:WORD_0
  v_add_u32_sdwa v61, v4, v118 dst_sel:DWORD dst_unused:UNUSED_PAD src0_sel:DWORD src1_sel:WORD_1
  v_add_u32_sdwa v62, v4, v119 dst_sel:DWORD dst_unused:UNUSED_PAD src0_sel:DWORD src1_sel:WORD_0
  v_add_u32_sdwa v63, v4, v119 dst_sel:DWORD dst_unused:UNUSED_PAD src0_sel:DWORD src1_sel:WORD_1
  ds_write_b32 v48, v96
  ds_write_b32 v49, v97
  ds_write_b32 v50, v98
  ds_write_b32 v51, v99
  ds_write_b32 v52, v100
  ds_write_b32 v53, v101
  ds_write_b32 v54, v102
  ds_write_b32 v55, v103
  ds_write_b32 v56, v104
  ds_write_b32 v57, v105
  ds_write_b32 v58, v106
  ds_write_b32 v59, v107
  ds_write_b32 v60, v108
  ds_write_b32 v61, v109
  ds_write_b32 v62, v110
  ds_write_b32 v63, v111
  s_mul_i32 s70, s67, 29184
  v_mov_b32 v4, s70
  v_add_u32_sdwa v48, v4, v120 dst_sel:DWORD dst_unused:UNUSED_PAD src0_sel:DWORD src1_sel:WORD_0
  v_add_u32_sdwa v49, v4, v120 dst_sel:DWORD dst_unused:UNUSED_PAD src0_sel:DWORD src1_sel:WORD_1
  v_add_u32_sdwa v50, v4, v121 dst_sel:DWORD dst_unused:UNUSED_PAD src0_sel:DWORD src1_sel:WORD_0
  v_add_u32_sdwa v51, v4, v121 dst_sel:DWORD dst_unused:UNUSED_PAD src0_sel:DWORD src1_sel:WORD_1
  v_add_u32_sdwa v52, v4, v122 dst_sel:DWORD dst_unused:UNUSED_PAD src0_sel:DWORD src1_sel:WORD_0
  v_add_u32_sdwa v53, v4, v122 dst_sel:DWORD dst_unused:UNUSED_PAD src0_sel:DWORD src1_sel:WORD_1
  v_add_u32_sdwa v54, v4, v123 dst_sel:DWORD dst_unused:UNUSED_PAD src0_sel:DWORD src1_sel:WORD_0
  v_add_u32_sdwa v55, v4, v123 dst_sel:DWORD dst_unused:UNUSED_PAD src0_sel:DWORD src1_sel:WORD_1
  v_add_u32_sdwa v56, v4, v124 dst_sel:DWORD dst_unused:UNUSED_PAD src0_sel:DWORD src1_sel:WORD_0
  v_add_u32_sdwa v57, v4, v124 dst_sel:DWORD dst_unused:UNUSED_PAD src0_sel:DWORD src1_sel:WORD_1
  v_add_u32_sdwa v58, v4, v125 dst_sel:DWORD dst_unused:UNUSED_PAD src0_sel:DWORD src1_sel:WORD_0
  v_add_u32_sdwa v59, v4, v125 dst_sel:DWORD dst_unused:UNUSED_PAD src0_sel:DWORD src1_sel:WORD_1
  v_add_u32_sdwa v60, v4, v126 dst_sel:DWORD dst_unused:UNUSED_PAD src0_sel:DWORD src1_sel:WORD_0
  v_add_u32_sdwa v61, v4, v126 dst_sel:DWORD dst_unused:UNUSED_PAD src0_sel:DWORD src1_sel:WORD_1
  v_add_u32_sdwa v62, v4, v127 dst_sel:DWORD dst_unused:UNUSED_PAD src0_sel:DWORD src1_sel:WORD_0
  v_add_u32_sdwa v63, v4, v127 dst_sel:DWORD dst_unused:UNUSED_PAD src0_sel:DWORD src1_sel:WORD_1
  s_waitcnt lgkmcnt(0)
  s_barrier
  ds_read_b32 v64, v48
  ds_read_b32 v80, v48 offset:14592
  ds_read_b32 v65, v49
  ds_read_b32 v81, v49 offset:14592
  ds_read_b32 v66, v50
  ds_read_b32 v82, v50 offset:14592
  ds_read_b32 v67, v51
  ds_read_b32 v83, v51 offset:14592
  ds_read_b32 v68, v52
  ds_read_b32 v84, v52 offset:14592
  ds_read_b32 v69, v53
  ds_read_b32 v85, v53 offset:14592
  ds_read_b32 v70, v54
  ds_read_b32 v86, v54 offset:14592
  ds_read_b32 v71, v55
  ds_read_b32 v87, v55 offset:14592
  ds_read_b32 v72, v56
  ds_read_b32 v88, v56 offset:14592
  ds_read_b32 v73, v57
  ds_read_b32 v89, v57 offset:14592
  ds_read_b32 v74, v58
  ds_read_b32 v90, v58 offset:14592
  ds_read_b32 v75, v59
  ds_read_b32 v91, v59 offset:14592
  ds_read_b32 v76, v60
  ds_read_b32 v92, v60 offset:14592
  ds_read_b32 v77, v61
  ds_read_b32 v93, v61 offset:14592
  ds_read_b32 v78, v62
  ds_read_b32 v94, v62 offset:14592
  ds_read_b32 v79, v63
  ds_read_b32 v95, v63 offset:14592
  s_mul_i32 s70, s67, 4608
  s_lshl_b32 s71, s60, 11
  s_add_u32 s70, s70, s71
  s_add_u32 s70, s70, 17408
  v_lshlrev_b32 v4, 2, v1
  v_add_u32 v4, s70, v4
  s_mul_i32 s70, s67, 4608
  s_add_u32 s70, s70, 21504
  v_lshlrev_b32 v5, 4, v1
  v_add_u32 v5, s70, v5
  v_mov_b32 v48, 0
  v_mov_b32 v49, 0
  v_mov_b32 v50, 0
  v_mov_b32 v51, 0
  s_waitcnt lgkmcnt(0)
  s_barrier
  v_pk_add_f32 v[64:65], v[64:65], v[80:81]
  v_pk_add_f32 v[66:67], v[66:67], v[82:83]
  v_pk_add_f32 v[68:69], v[68:69], v[84:85]
  v_pk_add_f32 v[70:71], v[70:71], v[86:87]
  v_pk_add_f32 v[72:73], v[72:73], v[88:89]
  v_pk_add_f32 v[74:75], v[74:75], v[90:91]
  v_pk_add_f32 v[76:77], v[76:77], v[92:93]
  v_pk_add_f32 v[78:79], v[78:79], v[94:95]
  v_cvt_pk_bf16_f32 v80, v64, v65
  v_cvt_pk_bf16_f32 v81, v66, v67
  v_cvt_pk_bf16_f32 v82, v68, v69
  v_cvt_pk_bf16_f32 v83, v70, v71
  v_cvt_pk_bf16_f32 v84, v72, v73
  v_cvt_pk_bf16_f32 v85, v74, v75
  v_cvt_pk_bf16_f32 v86, v76, v77
  v_cvt_pk_bf16_f32 v87, v78, v79
  ds_write_b32 v4, v80 offset:0
  ds_write_b32 v4, v81 offset:256
  ds_write_b32 v4, v82 offset:512
  ds_write_b32 v4, v83 offset:768
  ds_write_b32 v4, v84 offset:1024
  ds_write_b32 v4, v85 offset:1280
  ds_write_b32 v4, v86 offset:1536
  ds_write_b32 v4, v87 offset:1792
  s_mov_b32 exec_hi, 0
  ds_write_b128 v5, v[48:51]
  s_mov_b32 exec_hi, -1
  s_and_b32 s67, s3, 3
  s_lshr_b32 s60, s3, 2
  v_and_b32 v2, 15, v1
  v_lshrrev_b32 v3, 4, v1
  s_mul_i32 s70, s67, 4608
  s_add_u32 s70, s70, 17888
  v_lshlrev_b32 v4, 5, v2
  v_sub_u32 v4, s70, v4
  v_lshl_add_u32 v11, v3, 4, v4
  v_add_u32 v4, 1, v2
  v_and_b32 v4, 3, v4
  v_mul_u32_u24 v5, 4288, v4
  v_sub_u32 v4, v2, v4
  v_add_u32 v4, 49, v4
  v_lshl_add_u32 v4, v3, 3, v4
  v_lshl_add_u32 v4, v4, 1, v5
  s_mul_i32 s70, s67, 17152
  s_add_u32 s70, s70, 35840
  v_add_u32 v12, s70, v4
  v_lshlrev_b32 v4, 5, v2
  v_lshl_add_u32 v4, v3, 3, v4
  v_add_u32 v13, s70, v4
  s_lshl_b32 s70, s60, 8
  v_add_u32 v11, s70, v11
  v_add_u32 v12, s70, v12
  s_waitcnt lgkmcnt(0)
  s_barrier
  s_add_u32 s70, s66, s67
  s_lshl_b32 s70, s70, 1
  s_and_b32 s71, s70, 0xfffffffc
  s_add_u32 s6, s24, s71
  s_addc_u32 s7, s25, 0
  s_load_dword s62, s[6:7], 0
  s_and_b32 s72, s70, 2
  s_lshl_b32 s72, s72, 3
  v_mov_b32 v16, 0
  v_mov_b32 v17, 0
  v_mov_b32 v18, 0
  v_mov_b32 v19, 0
  v_mov_b32 v20, 0
  v_mov_b32 v21, 0
  v_mov_b32 v22, 0
  v_mov_b32 v23, 0
  v_mov_b32 v24, 0
  v_mov_b32 v25, 0
  v_mov_b32 v26, 0
  v_mov_b32 v27, 0
  v_mov_b32 v28, 0
  v_mov_b32 v29, 0
  v_mov_b32 v30, 0
  v_mov_b32 v31, 0
  v_mov_b32 v32, 0
  v_mov_b32 v33, 0
  v_mov_b32 v34, 0
  v_mov_b32 v35, 0
  v_mov_b32 v36, 0
  v_mov_b32 v37, 0
  v_mov_b32 v38, 0
  v_mov_b32 v39, 0
  v_mov_b32 v40, 0
  v_mov_b32 v41, 0
  v_mov_b32 v42, 0
  v_mov_b32 v43, 0
  v_mov_b32 v44, 0
  v_mov_b32 v45, 0
  v_mov_b32 v46, 0
  v_mov_b32 v47, 0
  ds_read_b128 v[48:51], v11 offset:3584
  ds_read_b128 v[52:55], v11 offset:3072
  ds_read_b128 v[56:59], v11 offset:2560
  ds_read_b128 v[60:63], v11 offset:2048
  ds_read_b128 v[64:67], v11 offset:1536
  ds_read_b128 v[68:71], v11 offset:1024
  ds_read_b128 v[72:75], v11 offset:512
  ds_read_b128 v[76:79], v11 offset:0
  ds_read_b64 v[80:81], v12 offset:0
  ds_read_b64 v[82:83], v12 offset:8
  ds_read_b64 v[84:85], v12 offset:512
  ds_read_b64 v[86:87], v12 offset:520
  ds_read_b64 v[88:89], v12 offset:1024
  ds_read_b64 v[90:91], v12 offset:1032
  ds_read_b64 v[92:93], v12 offset:1536
  ds_read_b64 v[94:95], v12 offset:1544
  ds_read_b64 v[96:97], v12 offset:2048
  ds_read_b64 v[98:99], v12 offset:2056
  ds_read_b64 v[100:101], v12 offset:2560
  ds_read_b64 v[102:103], v12 offset:2568
  ds_read_b64 v[104:105], v12 offset:3072
  ds_read_b64 v[106:107], v12 offset:3080
  ds_read_b64 v[108:109], v12 offset:3584
  ds_read_b64 v[110:111], v12 offset:3592
  v_add_u32 v11, 64, v11
  v_add_u32 v12, 64, v12
  s_mov_b32 s73, 0
  s_waitcnt lgkmcnt(0)
Lconv_42:
  s_waitcnt lgkmcnt(6)
  v_mfma_f32_16x16x32_bf16 v[44:47], v[80:83], v[76:79], v[44:47]
  v_mfma_f32_16x16x32_bf16 v[40:43], v[80:83], v[72:75], v[40:43]
  v_mfma_f32_16x16x32_bf16 v[36:39], v[80:83], v[68:71], v[36:39]
  v_mfma_f32_16x16x32_bf16 v[32:35], v[80:83], v[64:67], v[32:35]
  v_mfma_f32_16x16x32_bf16 v[28:31], v[80:83], v[60:63], v[28:31]
  v_mfma_f32_16x16x32_bf16 v[24:27], v[80:83], v[56:59], v[24:27]
  s_waitcnt lgkmcnt(3)
  v_mfma_f32_16x16x32_bf16 v[20:23], v[80:83], v[52:55], v[20:23]
  s_waitcnt lgkmcnt(0)
  v_mfma_f32_16x16x32_bf16 v[16:19], v[80:83], v[48:51], v[16:19]
  ds_read_b64 v[80:81], v12 offset:0
  ds_read_b64 v[82:83], v12 offset:8
  ds_read_b128 v[76:79], v11 offset:0
  v_mfma_f32_16x16x32_bf16 v[44:47], v[84:87], v[72:75], v[44:47]
  v_mfma_f32_16x16x32_bf16 v[40:43], v[84:87], v[68:71], v[40:43]
  v_mfma_f32_16x16x32_bf16 v[36:39], v[84:87], v[64:67], v[36:39]
  v_mfma_f32_16x16x32_bf16 v[32:35], v[84:87], v[60:63], v[32:35]
  v_mfma_f32_16x16x32_bf16 v[28:31], v[84:87], v[56:59], v[28:31]
  v_mfma_f32_16x16x32_bf16 v[24:27], v[84:87], v[52:55], v[24:27]
  v_mfma_f32_16x16x32_bf16 v[20:23], v[84:87], v[48:51], v[20:23]
  ds_read_b64 v[84:85], v12 offset:512
  ds_read_b64 v[86:87], v12 offset:520
  ds_read_b128 v[72:75], v11 offset:512
  v_mfma_f32_16x16x32_bf16 v[44:47], v[88:91], v[68:71], v[44:47]
  v_mfma_f32_16x16x32_bf16 v[40:43], v[88:91], v[64:67], v[40:43]
  v_mfma_f32_16x16x32_bf16 v[36:39], v[88:91], v[60:63], v[36:39]
  v_mfma_f32_16x16x32_bf16 v[32:35], v[88:91], v[56:59], v[32:35]
  v_mfma_f32_16x16x32_bf16 v[28:31], v[88:91], v[52:55], v[28:31]
  v_mfma_f32_16x16x32_bf16 v[24:27], v[88:91], v[48:51], v[24:27]
  ds_read_b64 v[88:89], v12 offset:1024
  ds_read_b64 v[90:91], v12 offset:1032
  ds_read_b128 v[68:71], v11 offset:1024
  v_mfma_f32_16x16x32_bf16 v[44:47], v[92:95], v[64:67], v[44:47]
  v_mfma_f32_16x16x32_bf16 v[40:43], v[92:95], v[60:63], v[40:43]
  v_mfma_f32_16x16x32_bf16 v[36:39], v[92:95], v[56:59], v[36:39]
  v_mfma_f32_16x16x32_bf16 v[32:35], v[92:95], v[52:55], v[32:35]
  v_mfma_f32_16x16x32_bf16 v[28:31], v[92:95], v[48:51], v[28:31]
  ds_read_b64 v[92:93], v12 offset:1536
  ds_read_b64 v[94:95], v12 offset:1544
  ds_read_b128 v[64:67], v11 offset:1536
  v_mfma_f32_16x16x32_bf16 v[44:47], v[96:99], v[60:63], v[44:47]
  v_mfma_f32_16x16x32_bf16 v[40:43], v[96:99], v[56:59], v[40:43]
  v_mfma_f32_16x16x32_bf16 v[36:39], v[96:99], v[52:55], v[36:39]
  v_mfma_f32_16x16x32_bf16 v[32:35], v[96:99], v[48:51], v[32:35]
  ds_read_b64 v[96:97], v12 offset:2048
  ds_read_b64 v[98:99], v12 offset:2056
  ds_read_b128 v[60:63], v11 offset:2048
  v_mfma_f32_16x16x32_bf16 v[44:47], v[100:103], v[56:59], v[44:47]
  v_mfma_f32_16x16x32_bf16 v[40:43], v[100:103], v[52:55], v[40:43]
  v_mfma_f32_16x16x32_bf16 v[36:39], v[100:103], v[48:51], v[36:39]
  ds_read_b64 v[100:101], v12 offset:2560
  ds_read_b64 v[102:103], v12 offset:2568
  ds_read_b128 v[56:59], v11 offset:2560
  v_mfma_f32_16x16x32_bf16 v[44:47], v[104:107], v[52:55], v[44:47]
  v_mfma_f32_16x16x32_bf16 v[40:43], v[104:107], v[48:51], v[40:43]
  ds_read_b64 v[104:105], v12 offset:3072
  ds_read_b64 v[106:107], v12 offset:3080
  ds_read_b128 v[52:55], v11 offset:3072
  v_mfma_f32_16x16x32_bf16 v[44:47], v[108:111], v[48:51], v[44:47]
  ds_read_b64 v[108:109], v12 offset:3584
  ds_read_b64 v[110:111], v12 offset:3592
  ds_read_b128 v[48:51], v11 offset:3584
  v_add_u32 v11, 64, v11
  v_add_u32 v12, 64, v12
  s_add_u32 s73, s73, 1
  s_cmp_lt_u32 s73, 4
  s_cbranch_scc1 Lconv_42
  s_waitcnt lgkmcnt(0)
  v_lshlrev_b32 v2, 4, v1
  s_mul_i32 s70, s67, 17152
  s_lshl_b32 s71, s60, 12
  s_add_u32 s70, s70, 40128
  s_add_u32 s71, s71, s70
  v_add_u32 v5, s71, v2
  s_lshl_b32 s71, s60, 12
  s_xor_b32 s71, s71, 4096
  s_add_u32 s71, s71, s70
  v_add_u32 v2, s71, v2
  s_barrier
  s_cmp_eq_u32 s60, 0
  s_cbranch_scc1 Lcv_lo
  ds_write_b128 v5, v[16:19] offset:0
  ds_write_b128 v5, v[20:23] offset:1024
  ds_write_b128 v5, v[24:27] offset:2048
  ds_write_b128 v5, v[28:31] offset:3072
  ds_read_b64 v[48:49], v13 offset:2176
  ds_read_b64 v[50:51], v13 offset:2688
  ds_read_b64 v[52:53], v13 offset:3200
  ds_read_b64 v[54:55], v13 offset:3712
  s_waitcnt lgkmcnt(0)
  s_barrier
  ds_read_b128 v[80:83], v2 offset:0
  ds_read_b128 v[84:87], v2 offset:1024
  ds_read_b128 v[88:91], v2 offset:2048
  ds_read_b128 v[92:95], v2 offset:3072
  s_lshr_b32 s62, s62, s72
  s_lshl_b32 s62, s62, 16
  v_and_b32 v2, 15, v1
  v_lshrrev_b32 v3, 4, v1
  v_mul_u32_u24 v4, 136, v2
  v_lshl_add_u32 v4, v3, 5, v4
  s_lshl_b32 s70, s67, 1
  v_add_u32 v4, s70, v4
  v_mov_b32 v68, s62
  s_waitcnt lgkmcnt(0)
  v_pk_add_f32 v[32:33], v[32:33], v[80:81]
  v_pk_add_f32 v[34:35], v[34:35], v[82:83]
  v_lshlrev_b32 v64, 16, v48
  v_and_b32 v65, 0xffff0000, v48
  v_lshlrev_b32 v66, 16, v49
  v_and_b32 v67, 0xffff0000, v49
  v_pk_fma_f32 v[64:65], v[64:65], v[68:69], v[32:33] op_sel_hi:[1,0,1]
  v_pk_fma_f32 v[66:67], v[66:67], v[68:69], v[34:35] op_sel_hi:[1,0,1]
  v_cvt_pk_bf16_f32 v48, v64, v65
  v_cvt_pk_bf16_f32 v49, v66, v67
  v_pk_add_f32 v[36:37], v[36:37], v[84:85]
  v_pk_add_f32 v[38:39], v[38:39], v[86:87]
  v_lshlrev_b32 v64, 16, v50
  v_and_b32 v65, 0xffff0000, v50
  v_lshlrev_b32 v66, 16, v51
  v_and_b32 v67, 0xffff0000, v51
  v_pk_fma_f32 v[64:65], v[64:65], v[68:69], v[36:37] op_sel_hi:[1,0,1]
  v_pk_fma_f32 v[66:67], v[66:67], v[68:69], v[38:39] op_sel_hi:[1,0,1]
  v_cvt_pk_bf16_f32 v50, v64, v65
  v_cvt_pk_bf16_f32 v51, v66, v67
  v_pk_add_f32 v[40:41], v[40:41], v[88:89]
  v_pk_add_f32 v[42:43], v[42:43], v[90:91]
  v_lshlrev_b32 v64, 16, v52
  v_and_b32 v65, 0xffff0000, v52
  v_lshlrev_b32 v66, 16, v53
  v_and_b32 v67, 0xffff0000, v53
  v_pk_fma_f32 v[64:65], v[64:65], v[68:69], v[40:41] op_sel_hi:[1,0,1]
  v_pk_fma_f32 v[66:67], v[66:67], v[68:69], v[42:43] op_sel_hi:[1,0,1]
  v_cvt_pk_bf16_f32 v52, v64, v65
  v_cvt_pk_bf16_f32 v53, v66, v67
  v_pk_add_f32 v[44:45], v[44:45], v[92:93]
  v_pk_add_f32 v[46:47], v[46:47], v[94:95]
  v_lshlrev_b32 v64, 16, v54
  v_and_b32 v65, 0xffff0000, v54
  v_lshlrev_b32 v66, 16, v55
  v_and_b32 v67, 0xffff0000, v55
  v_pk_fma_f32 v[64:65], v[64:65], v[68:69], v[44:45] op_sel_hi:[1,0,1]
  v_pk_fma_f32 v[66:67], v[66:67], v[68:69], v[46:47] op_sel_hi:[1,0,1]
  v_cvt_pk_bf16_f32 v54, v64, v65
  v_cvt_pk_bf16_f32 v55, v66, v67
  ds_write_b16 v4, v48 offset:8704
  ds_write_b16_d16_hi v4, v48 offset:8712
  ds_write_b16 v4, v49 offset:8720
  ds_write_b16_d16_hi v4, v49 offset:8728
  ds_write_b16 v4, v50 offset:10880
  ds_write_b16_d16_hi v4, v50 offset:10888
  ds_write_b16 v4, v51 offset:10896
  ds_write_b16_d16_hi v4, v51 offset:10904
  ds_write_b16 v4, v52 offset:13056
  ds_write_b16_d16_hi v4, v52 offset:13064
  ds_write_b16 v4, v53 offset:13072
  ds_write_b16_d16_hi v4, v53 offset:13080
  ds_write_b16 v4, v54 offset:15232
  ds_write_b16_d16_hi v4, v54 offset:15240
  ds_write_b16 v4, v55 offset:15248
  ds_write_b16_d16_hi v4, v55 offset:15256
  s_branch Lcve_41
Lcv_lo:
  ds_write_b128 v5, v[32:35] offset:0
  ds_write_b128 v5, v[36:39] offset:1024
  ds_write_b128 v5, v[40:43] offset:2048
  ds_write_b128 v5, v[44:47] offset:3072
  ds_read_b64 v[48:49], v13 offset:128
  ds_read_b64 v[50:51], v13 offset:640
  ds_read_b64 v[52:53], v13 offset:1152
  ds_read_b64 v[54:55], v13 offset:1664
  s_waitcnt lgkmcnt(0)
  s_barrier
  ds_read_b128 v[80:83], v2 offset:0
  ds_read_b128 v[84:87], v2 offset:1024
  ds_read_b128 v[88:91], v2 offset:2048
  ds_read_b128 v[92:95], v2 offset:3072
  s_lshr_b32 s62, s62, s72
  s_lshl_b32 s62, s62, 16
  v_and_b32 v2, 15, v1
  v_lshrrev_b32 v3, 4, v1
  v_mul_u32_u24 v4, 136, v2
  v_lshl_add_u32 v4, v3, 5, v4
  s_lshl_b32 s70, s67, 1
  v_add_u32 v4, s70, v4
  v_mov_b32 v68, s62
  s_waitcnt lgkmcnt(0)
  v_pk_add_f32 v[16:17], v[16:17], v[80:81]
  v_pk_add_f32 v[18:19], v[18:19], v[82:83]
  v_lshlrev_b32 v64, 16, v48
  v_and_b32 v65, 0xffff0000, v48
  v_lshlrev_b32 v66, 16, v49
  v_and_b32 v67, 0xffff0000, v49
  v_pk_fma_f32 v[64:65], v[64:65], v[68:69], v[16:17] op_sel_hi:[1,0,1]
  v_pk_fma_f32 v[66:67], v[66:67], v[68:69], v[18:19] op_sel_hi:[1,0,1]
  v_cvt_pk_bf16_f32 v48, v64, v65
  v_cvt_pk_bf16_f32 v49, v66, v67
  v_pk_add_f32 v[20:21], v[20:21], v[84:85]
  v_pk_add_f32 v[22:23], v[22:23], v[86:87]
  v_lshlrev_b32 v64, 16, v50
  v_and_b32 v65, 0xffff0000, v50
  v_lshlrev_b32 v66, 16, v51
  v_and_b32 v67, 0xffff0000, v51
  v_pk_fma_f32 v[64:65], v[64:65], v[68:69], v[20:21] op_sel_hi:[1,0,1]
  v_pk_fma_f32 v[66:67], v[66:67], v[68:69], v[22:23] op_sel_hi:[1,0,1]
  v_cvt_pk_bf16_f32 v50, v64, v65
  v_cvt_pk_bf16_f32 v51, v66, v67
  v_pk_add_f32 v[24:25], v[24:25], v[88:89]
  v_pk_add_f32 v[26:27], v[26:27], v[90:91]
  v_lshlrev_b32 v64, 16, v52
  v_and_b32 v65, 0xffff0000, v52
  v_lshlrev_b32 v66, 16, v53
  v_and_b32 v67, 0xffff0000, v53
  v_pk_fma_f32 v[64:65], v[64:65], v[68:69], v[24:25] op_sel_hi:[1,0,1]
  v_pk_fma_f32 v[66:67], v[66:67], v[68:69], v[26:27] op_sel_hi:[1,0,1]
  v_cvt_pk_bf16_f32 v52, v64, v65
  v_cvt_pk_bf16_f32 v53, v66, v67
  v_pk_add_f32 v[28:29], v[28:29], v[92:93]
  v_pk_add_f32 v[30:31], v[30:31], v[94:95]
  v_lshlrev_b32 v64, 16, v54
  v_and_b32 v65, 0xffff0000, v54
  v_lshlrev_b32 v66, 16, v55
  v_and_b32 v67, 0xffff0000, v55
  v_pk_fma_f32 v[64:65], v[64:65], v[68:69], v[28:29] op_sel_hi:[1,0,1]
  v_pk_fma_f32 v[66:67], v[66:67], v[68:69], v[30:31] op_sel_hi:[1,0,1]
  v_cvt_pk_bf16_f32 v54, v64, v65
  v_cvt_pk_bf16_f32 v55, v66, v67
  ds_write_b16 v4, v48 offset:0
  ds_write_b16_d16_hi v4, v48 offset:8
  ds_write_b16 v4, v49 offset:16
  ds_write_b16_d16_hi v4, v49 offset:24
  ds_write_b16 v4, v50 offset:2176
  ds_write_b16_d16_hi v4, v50 offset:2184
  ds_write_b16 v4, v51 offset:2192
  ds_write_b16_d16_hi v4, v51 offset:2200
  ds_write_b16 v4, v52 offset:4352
  ds_write_b16_d16_hi v4, v52 offset:4360
  ds_write_b16 v4, v53 offset:4368
  ds_write_b16_d16_hi v4, v53 offset:4376
  ds_write_b16 v4, v54 offset:6528
  ds_write_b16_d16_hi v4, v54 offset:6536
  ds_write_b16 v4, v55 offset:6544
  ds_write_b16_d16_hi v4, v55 offset:6552
Lcve_41:
  s_waitcnt lgkmcnt(0)
  s_barrier
  s_cmp_eq_u32 s69, 7
  s_cbranch_scc1 Lnc3_43
  s_barrier
Lnc3_43:
  s_cmp_lt_u32 s3, 4
  s_cbranch_scc1 Lnys_44
  s_mov_b32 s56, s34
  s_and_b32 s57, s35, 0xffff
  s_mov_b32 s58, 3670016
  s_mov_b32 s59, 0x20000
  s_sub_u32 s70, s3, 4
  s_lshl_b32 s70, s70, 9
  v_add_u32 v2, s70, v1
  v_lshrrev_b32 v3, 4, v2
  v_add_u32 v3, v3, v2
  v_lshlrev_b32 v3, 3, v3
  ds_read_b64 v[16:17], v3 offset:0
  ds_read_b64 v[18:19], v3 offset:544
  ds_read_b64 v[20:21], v3 offset:1088
  ds_read_b64 v[22:23], v3 offset:1632
  ds_read_b64 v[24:25], v3 offset:2176
  ds_read_b64 v[26:27], v3 offset:2720
  ds_read_b64 v[28:29], v3 offset:3264
  ds_read_b64 v[30:31], v3 offset:3808
  v_mul_u32_u24 v2, 1792, v2
  s_lshl_b32 s70, s66, 1
  s_waitcnt lgkmcnt(7)
  buffer_store_dwordx2 v[16:17], v2, s[56:59], s70 offen
  s_add_u32 s70, s70, 114688
  s_waitcnt lgkmcnt(6)
  buffer_store_dwordx2 v[18:19], v2, s[56:59], s70 offen
  s_add_u32 s70, s70, 114688
  s_waitcnt lgkmcnt(5)
  buffer_store_dwordx2 v[20:21], v2, s[56:59], s70 offen
  s_add_u32 s70, s70, 114688
  s_waitcnt lgkmcnt(4)
  buffer_store_dwordx2 v[22:23], v2, s[56:59], s70 offen
  s_add_u32 s70, s70, 114688
  s_waitcnt lgkmcnt(3)
  buffer_store_dwordx2 v[24:25], v2, s[56:59], s70 offen
  s_add_u32 s70, s70, 114688
  s_waitcnt lgkmcnt(2)
  buffer_store_dwordx2 v[26:27], v2, s[56:59], s70 offen
  s_add_u32 s70, s70, 114688
  s_waitcnt lgkmcnt(1)
  buffer_store_dwordx2 v[28:29], v2, s[56:59], s70 offen
  s_add_u32 s70, s70, 114688
  s_waitcnt lgkmcnt(0)
  buffer_store_dwordx2 v[30:31], v2, s[56:59], s70 offen
Lnys_44:
  s_cmp_eq_u32 s69, 7
  s_cbranch_scc1 Lexit
  s_cmp_lt_u32 s3, 4
  s_cbranch_scc1 Lfinal
  s_barrier
  s_endpgm
La_u:
  s_sub_u32 s74, s3, 8
  s_waitcnt lgkmcnt(0)
  s_mov_b32 s40, s8
  s_and_b32 s41, s9, 0xffff
  s_mov_b32 s42, 1835008
  s_mov_b32 s43, 0x20000
  s_mov_b32 s48, s38
  s_and_b32 s49, s39, 0xffff
  s_mov_b32 s50, 268435456
  s_mov_b32 s51, 0x20000
  s_mov_b32 s52, s32
  s_and_b32 s53, s33, 0xffff
  s_mov_b32 s54, 401408
  s_mov_b32 s55, 0x20000
  s_load_dword s5, s[38:39], 0
  s_cmp_eq_u32 s3, 10
  s_cbranch_scc1 La_u10
  s_cmp_eq_u32 s3, 11
  s_cbranch_scc1 La_u11
  s_sub_u32 s67, s65, 16
  s_lshl_b32 s67, s67, 1
  s_add_u32 s67, s67, s74
  v_lshrrev_b32 v2, 3, v1
  v_and_b32 v3, 7, v1
  v_lshlrev_b32 v3, 4, v3
  v_mul_u32_u24 v10, 896, v2
  v_add_u32 v10, v10, v3
  v_mul_u32_u24 v11, 4224, v2
  v_add_u32 v11, v11, v3
  s_mul_i32 s70, s67, 57344
  s_lshl_b32 s71, s64, 7
  s_add_u32 s70, s70, s71
  s_mul_i32 s72, s64, 270336
  s_add_u32 s72, s72, 4194304
  s_mov_b32 s77, s72
  s_lshl_b32 s71, s67, 7
  s_add_u32 s72, s72, s71
  s_add_u32 s72, s72, 128
  buffer_load_dwordx4 v[16:19], v10, s[40:43], s70 offen
  s_add_u32 s70, s70, 7168
  buffer_load_dwordx4 v[20:23], v10, s[40:43], s70 offen
  s_add_u32 s70, s70, 7168
  buffer_load_dwordx4 v[24:27], v10, s[40:43], s70 offen
  s_add_u32 s70, s70, 7168
  buffer_load_dwordx4 v[28:31], v10, s[40:43], s70 offen
  s_add_u32 s70, s70, 7168
  buffer_load_dwordx4 v[32:35], v10, s[40:43], s70 offen
  s_add_u32 s70, s70, 7168
  buffer_load_dwordx4 v[36:39], v10, s[40:43], s70 offen
  s_add_u32 s70, s70, 7168
  buffer_load_dwordx4 v[40:43], v10, s[40:43], s70 offen
  s_add_u32 s70, s70, 7168
  buffer_load_dwordx4 v[44:47], v10, s[40:43], s70 offen
  s_add_u32 s70, s70, 7168
  v_mov_b32 v84, 0
  v_mov_b32 v85, 0
  v_mov_b32 v86, 0
  v_mov_b32 v87, 0
  s_cmp_eq_u32 s67, 0
  s_cselect_b32 s71, 0, 0x7ff00000
  v_add_u32 v13, s71, v11
  s_mov_b32 s71, s77
  buffer_store_dwordx4 v[84:87], v13, s[48:51], s71 offen sc1
  s_add_u32 s71, s71, 33792
  buffer_store_dwordx4 v[84:87], v13, s[48:51], s71 offen sc1
  s_add_u32 s71, s71, 33792
  buffer_store_dwordx4 v[84:87], v13, s[48:51], s71 offen sc1
  s_add_u32 s71, s71, 33792
  buffer_store_dwordx4 v[84:87], v13, s[48:51], s71 offen sc1
  s_add_u32 s71, s71, 33792
  buffer_store_dwordx4 v[84:87], v13, s[48:51], s71 offen sc1
  s_add_u32 s71, s71, 33792
  buffer_store_dwordx4 v[84:87], v13, s[48:51], s71 offen sc1
  s_add_u32 s71, s71, 33792
  buffer_store_dwordx4 v[84:87], v13, s[48:51], s71 offen sc1
  s_add_u32 s71, s71, 33792
  buffer_store_dwordx4 v[84:87], v13, s[48:51], s71 offen sc1
  s_add_u32 s71, s71, 33792
  v_lshrrev_b32 v7, 3, v1
  v_mul_u32_u24 v7, 144, v7
  v_and_b32 v8, 7, v1
  v_lshl_add_u32 v7, v8, 4, v7
  v_add_u32 v4, 120832, v7
  v_lshrrev_b32 v7, 4, v1
  v_lshrrev_b32 v8, 2, v1
  v_and_b32 v8, 3, v8
  v_lshl_add_u32 v8, v7, 3, v8
  v_mul_u32_u24 v8, 144, v8
  v_and_b32 v9, 3, v1
  v_lshl_add_u32 v8, v9, 3, v8
  v_add_u32 v5, 120832, v8
  v_and_b32 v8, 15, v1
  v_mul_u32_u24 v8, 144, v8
  v_lshl_add_u32 v8, v7, 4, v8
  v_add_u32 v6, 130048, v8
  s_mul_i32 s75, s74, 18432
  v_add_u32 v4, s75, v4
  v_add_u32 v5, s75, v5
  v_add_u32 v6, s75, v6
  s_waitcnt vmcnt(15)
  ds_write_b128 v4, v[16:19] offset:0
  s_waitcnt vmcnt(14)
  ds_write_b128 v4, v[20:23] offset:1152
  s_waitcnt vmcnt(13)
  ds_write_b128 v4, v[24:27] offset:2304
  s_waitcnt vmcnt(12)
  ds_write_b128 v4, v[28:31] offset:3456
  s_waitcnt vmcnt(11)
  ds_write_b128 v4, v[32:35] offset:4608
  s_waitcnt vmcnt(10)
  ds_write_b128 v4, v[36:39] offset:5760
  s_waitcnt vmcnt(9)
  ds_write_b128 v4, v[40:43] offset:6912
  s_waitcnt vmcnt(8)
  ds_write_b128 v4, v[44:47] offset:8064
  s_waitcnt lgkmcnt(0)
  ds_read_b64_tr_b16 v[48:49], v5 offset:0
  ds_read_b64_tr_b16 v[50:51], v5 offset:576
  ds_read_b64_tr_b16 v[52:53], v5 offset:4608
  ds_read_b64_tr_b16 v[54:55], v5 offset:5184
  ds_read_b64_tr_b16 v[56:57], v5 offset:32
  ds_read_b64_tr_b16 v[58:59], v5 offset:608
  ds_read_b64_tr_b16 v[60:61], v5 offset:4640
  ds_read_b64_tr_b16 v[62:63], v5 offset:5216
  ds_read_b64_tr_b16 v[64:65], v5 offset:64
  ds_read_b64_tr_b16 v[66:67], v5 offset:640
  ds_read_b64_tr_b16 v[68:69], v5 offset:4672
  ds_read_b64_tr_b16 v[70:71], v5 offset:5248
  ds_read_b64_tr_b16 v[72:73], v5 offset:96
  ds_read_b64_tr_b16 v[74:75], v5 offset:672
  ds_read_b64_tr_b16 v[76:77], v5 offset:4704
  ds_read_b64_tr_b16 v[78:79], v5 offset:5280
  s_waitcnt lgkmcnt(0)
  ds_write_b128 v6, v[48:51] offset:0
  ds_write_b128 v6, v[52:55] offset:64
  ds_write_b128 v6, v[56:59] offset:2304
  ds_write_b128 v6, v[60:63] offset:2368
  ds_write_b128 v6, v[64:67] offset:4608
  ds_write_b128 v6, v[68:71] offset:4672
  ds_write_b128 v6, v[72:75] offset:6912
  ds_write_b128 v6, v[76:79] offset:6976
  s_waitcnt lgkmcnt(0)
  v_add_u32 v4, 9216, v4
  ds_read_b128 v[16:19], v4 offset:0
  ds_read_b128 v[20:23], v4 offset:1152
  ds_read_b128 v[24:27], v4 offset:2304
  ds_read_b128 v[28:31], v4 offset:3456
  ds_read_b128 v[32:35], v4 offset:4608
  ds_read_b128 v[36:39], v4 offset:5760
  ds_read_b128 v[40:43], v4 offset:6912
  ds_read_b128 v[44:47], v4 offset:8064
  s_waitcnt lgkmcnt(7)
  buffer_store_dwordx4 v[16:19], v11, s[48:51], s72 offen sc1
  s_add_u32 s72, s72, 33792
  s_waitcnt lgkmcnt(6)
  buffer_store_dwordx4 v[20:23], v11, s[48:51], s72 offen sc1
  s_add_u32 s72, s72, 33792
  s_waitcnt lgkmcnt(5)
  buffer_store_dwordx4 v[24:27], v11, s[48:51], s72 offen sc1
  s_add_u32 s72, s72, 33792
  s_waitcnt lgkmcnt(4)
  buffer_store_dwordx4 v[28:31], v11, s[48:51], s72 offen sc1
  s_add_u32 s72, s72, 33792
  s_waitcnt lgkmcnt(3)
  buffer_store_dwordx4 v[32:35], v11, s[48:51], s72 offen sc1
  s_add_u32 s72, s72, 33792
  s_waitcnt lgkmcnt(2)
  buffer_store_dwordx4 v[36:39], v11, s[48:51], s72 offen sc1
  s_add_u32 s72, s72, 33792
  s_waitcnt lgkmcnt(1)
  buffer_store_dwordx4 v[40:43], v11, s[48:51], s72 offen sc1
  s_add_u32 s72, s72, 33792
  s_waitcnt lgkmcnt(0)
  buffer_store_dwordx4 v[44:47], v11, s[48:51], s72 offen sc1
  s_add_u32 s72, s72, 33792
  s_waitcnt vmcnt(0) lgkmcnt(0)
  s_mul_i32 s4, s5, 0x9e3779b1
  s_add_u32 s4, s4, 0x85ebca6b
  s_lshl_b32 s70, s64, 5
  s_add_u32 s71, s70, s67
  s_lshl_b32 s71, s71, 7
  s_add_u32 s71, s71, 102400
  v_mov_b32 v2, s71
  v_mov_b32 v3, s4
  s_mov_b64 exec, 1
  buffer_store_dword v3, v2, s[48:51], 0 offen sc1
  s_mov_b64 exec, -1
  s_lshl_b32 s70, s74, 2
  s_add_u32 s70, s70, 163832
  v_mov_b32 v2, s70
  v_mov_b32 v3, s4
  s_mov_b64 exec, 1
  ds_write_b32 v2, v3
  s_mov_b64 exec, -1
  s_branch La_u4
La_u11:
  s_mul_i32 s70, s65, 98
  v_add_u32 v8, s70, v1
  v_lshlrev_b32 v8, 7, v8
  buffer_load_dword v44, v8, s[52:55], 0 offen
  v_min_u32 v9, 33, v1
  s_add_u32 s70, s70, 64
  v_add_u32 v9, s70, v9
  v_lshlrev_b32 v9, 7, v9
  buffer_load_dword v45, v9, s[52:55], 0 offen
  s_branch La_u4
La_u10:
  s_waitcnt lgkmcnt(0)
  s_mul_i32 s4, s5, 0x9e3779b1
  s_add_u32 s4, s4, 0x85ebca6b
  s_lshl_b32 s70, s64, 12
  s_add_u32 s70, s70, 102400
  v_and_b32 v2, 31, v1
  v_lshlrev_b32 v2, 7, v2
  v_add_u32 v2, s70, v2
  v_and_b32 v6, 1, v1
  v_lshlrev_b32 v6, 2, v6
  v_add_u32 v6, 163832, v6
  s_mov_b32 s6, 0
Lmw_45:
  ds_read_b32 v7, v6
  s_add_u32 s6, s6, 1
  s_waitcnt lgkmcnt(0)
  v_cmp_ne_u32 vcc, s4, v7
  s_cmp_gt_u32 s6, 100000
  s_cbranch_scc1 Lmwd_46
  s_cbranch_vccz Lmwd_46
  s_sleep 4
  s_branch Lmw_45
Lmwd_46:
  s_mov_b32 exec_hi, 0
  s_mov_b32 s6, 0
Lpoll_47:
  buffer_load_dword v3, v2, s[48:51], 0 offen sc1
  s_add_u32 s6, s6, 1
  s_waitcnt vmcnt(0)
  v_cmp_ne_u32 vcc, s4, v3
  s_cmp_gt_u32 s6, 100000
  s_cbranch_scc1 Lpdone_48
  s_cbranch_vccz Lpdone_48
  s_mov_b64 exec, vcc
  s_sleep 16
  s_branch Lpoll_47
Lpdone_48:
  s_mov_b64 exec, -1
  v_lshlrev_b32 v4, 4, v1
  s_mul_i32 s70, s66, 4224
  s_add_u32 s70, s70, 4194304
  s_mov_b32 m0, 120832
  s_nop 0
  buffer_load_dwordx4 v4, s[48:51], s70 offen offset:0 sc1 lds
  buffer_load_dwordx4 v4, s[48:51], s70 offen offset:1024 sc1 lds
  buffer_load_dwordx4 v4, s[48:51], s70 offen offset:2048 sc1 lds
  buffer_load_dwordx4 v4, s[48:51], s70 offen offset:3072 sc1 lds
  s_add_u32 m0, m0, 4096
  s_add_u32 s71, s70, 4096
  s_mov_b64 exec, 0xff
  buffer_load_dwordx4 v4, s[48:51], s71 offen sc1 lds
  s_mov_b64 exec, -1
  s_add_u32 s70, s70, 4224
  s_mov_b32 m0, 125120
  s_nop 0
  buffer_load_dwordx4 v4, s[48:51], s70 offen offset:0 sc1 lds
  buffer_load_dwordx4 v4, s[48:51], s70 offen offset:1024 sc1 lds
  buffer_load_dwordx4 v4, s[48:51], s70 offen offset:2048 sc1 lds
  buffer_load_dwordx4 v4, s[48:51], s70 offen offset:3072 sc1 lds
  s_add_u32 m0, m0, 4096
  s_add_u32 s71, s70, 4096
  s_mov_b64 exec, 0xff
  buffer_load_dwordx4 v4, s[48:51], s71 offen sc1 lds
  s_mov_b64 exec, -1
  s_add_u32 s70, s70, 4224
  s_mov_b32 m0, 129408
  s_nop 0
  buffer_load_dwordx4 v4, s[48:51], s70 offen offset:0 sc1 lds
  buffer_load_dwordx4 v4, s[48:51], s70 offen offset:1024 sc1 lds
  buffer_load_dwordx4 v4, s[48:51], s70 offen offset:2048 sc1 lds
  buffer_load_dwordx4 v4, s[48:51], s70 offen offset:3072 sc1 lds
  s_add_u32 m0, m0, 4096
  s_add_u32 s71, s70, 4096
  s_mov_b64 exec, 0xff
  buffer_load_dwordx4 v4, s[48:51], s71 offen sc1 lds
  s_mov_b64 exec, -1
  s_add_u32 s70, s70, 4224
  s_mov_b32 m0, 133696
  s_nop 0
  buffer_load_dwordx4 v4, s[48:51], s70 offen offset:0 sc1 lds
  buffer_load_dwordx4 v4, s[48:51], s70 offen offset:1024 sc1 lds
  buffer_load_dwordx4 v4, s[48:51], s70 offen offset:2048 sc1 lds
  buffer_load_dwordx4 v4, s[48:51], s70 offen offset:3072 sc1 lds
  s_add_u32 m0, m0, 4096
  s_add_u32 s71, s70, 4096
  s_mov_b64 exec, 0xff
  buffer_load_dwordx4 v4, s[48:51], s71 offen sc1 lds
  s_mov_b64 exec, -1
  s_add_u32 s70, s70, 4224
  s_waitcnt vmcnt(0)
La_u4:
  s_waitcnt lgkmcnt(0)
  s_barrier
  s_cmp_lg_u32 s3, 8
  s_cbranch_scc1 Lu8_49
  s_waitcnt lgkmcnt(0)
  v_mov_b32 v40, 0
  v_mov_b32 v41, 1
  s_mov_b64 exec, 1
  global_atomic_add v40, v41, s[36:37] sc1
  s_mov_b64 exec, -1
Lu8_49:
  v_lshlrev_b32 v4, 4, v1
  s_mul_i32 s70, s74, 17152
  s_add_u32 s70, s70, 35840
  v_add_u32 v5, s70, v4
  s_mul_i32 s70, s74, 4288
  s_add_u32 s70, s70, 120832
  v_add_u32 v6, s70, v4
  ds_read_b128 v[16:19], v6 offset:0
  ds_read_b128 v[20:23], v6 offset:16
  ds_read_b128 v[24:27], v6 offset:1024
  ds_read_b128 v[28:31], v6 offset:1040
  ds_read_b128 v[32:35], v6 offset:2048
  ds_read_b128 v[36:39], v6 offset:2064
  ds_read_b128 v[40:43], v6 offset:3072
  ds_read_b128 v[44:47], v6 offset:3088
  ds_read_b128 v[48:51], v6 offset:4096
  ds_read_b128 v[52:55], v6 offset:4112
  s_waitcnt lgkmcnt(0)
  s_barrier
  v_alignbit_b32 v64, v17, v16, 16
  v_mov_b32 v68, v17
  v_alignbit_b32 v72, v18, v17, 16
  v_alignbit_b32 v65, v18, v17, 16
  v_mov_b32 v69, v18
  v_alignbit_b32 v73, v19, v18, 16
  v_alignbit_b32 v66, v19, v18, 16
  v_mov_b32 v70, v19
  v_alignbit_b32 v74, v20, v19, 16
  v_alignbit_b32 v67, v20, v19, 16
  v_mov_b32 v71, v20
  v_alignbit_b32 v75, v21, v20, 16
  ds_write_b128 v5, v[16:19] offset:0
  ds_write_b128 v5, v[64:67] offset:4288
  ds_write_b128 v5, v[68:71] offset:8576
  ds_write_b128 v5, v[72:75] offset:12864
  v_alignbit_b32 v76, v25, v24, 16
  v_mov_b32 v80, v25
  v_alignbit_b32 v84, v26, v25, 16
  v_alignbit_b32 v77, v26, v25, 16
  v_mov_b32 v81, v26
  v_alignbit_b32 v85, v27, v26, 16
  v_alignbit_b32 v78, v27, v26, 16
  v_mov_b32 v82, v27
  v_alignbit_b32 v86, v28, v27, 16
  v_alignbit_b32 v79, v28, v27, 16
  v_mov_b32 v83, v28
  v_alignbit_b32 v87, v29, v28, 16
  ds_write_b128 v5, v[24:27] offset:1024
  ds_write_b128 v5, v[76:79] offset:5312
  ds_write_b128 v5, v[80:83] offset:9600
  ds_write_b128 v5, v[84:87] offset:13888
  s_waitcnt lgkmcnt(4)
  v_alignbit_b32 v64, v33, v32, 16
  v_mov_b32 v68, v33
  v_alignbit_b32 v72, v34, v33, 16
  v_alignbit_b32 v65, v34, v33, 16
  v_mov_b32 v69, v34
  v_alignbit_b32 v73, v35, v34, 16
  v_alignbit_b32 v66, v35, v34, 16
  v_mov_b32 v70, v35
  v_alignbit_b32 v74, v36, v35, 16
  v_alignbit_b32 v67, v36, v35, 16
  v_mov_b32 v71, v36
  v_alignbit_b32 v75, v37, v36, 16
  ds_write_b128 v5, v[32:35] offset:2048
  ds_write_b128 v5, v[64:67] offset:6336
  ds_write_b128 v5, v[68:71] offset:10624
  ds_write_b128 v5, v[72:75] offset:14912
  s_waitcnt lgkmcnt(4)
  v_alignbit_b32 v76, v41, v40, 16
  v_mov_b32 v80, v41
  v_alignbit_b32 v84, v42, v41, 16
  v_alignbit_b32 v77, v42, v41, 16
  v_mov_b32 v81, v42
  v_alignbit_b32 v85, v43, v42, 16
  v_alignbit_b32 v78, v43, v42, 16
  v_mov_b32 v82, v43
  v_alignbit_b32 v86, v44, v43, 16
  v_alignbit_b32 v79, v44, v43, 16
  v_mov_b32 v83, v44
  v_alignbit_b32 v87, v45, v44, 16
  ds_write_b128 v5, v[40:43] offset:3072
  ds_write_b128 v5, v[76:79] offset:7360
  ds_write_b128 v5, v[80:83] offset:11648
  ds_write_b128 v5, v[84:87] offset:15936
  s_waitcnt lgkmcnt(4)
  v_alignbit_b32 v64, v49, v48, 16
  v_mov_b32 v68, v49
  v_alignbit_b32 v72, v50, v49, 16
  v_alignbit_b32 v65, v50, v49, 16
  v_mov_b32 v69, v50
  v_alignbit_b32 v73, v51, v50, 16
  v_alignbit_b32 v66, v51, v50, 16
  v_mov_b32 v70, v51
  v_alignbit_b32 v74, v52, v51, 16
  v_alignbit_b32 v67, v52, v51, 16
  v_mov_b32 v71, v52
  v_alignbit_b32 v75, v53, v52, 16
  s_mov_b64 exec, 0xff
  ds_write_b128 v5, v[48:51] offset:4096
  ds_write_b128 v5, v[64:67] offset:8384
  ds_write_b128 v5, v[68:71] offset:12672
  ds_write_b128 v5, v[72:75] offset:16960
  s_mov_b64 exec, -1
  s_waitcnt lgkmcnt(4)
  s_waitcnt lgkmcnt(0)
  s_barrier
  s_cmp_lg_u32 s3, 8
  s_cbranch_scc1 Lexit
  s_cmp_eq_u32 s69, 7
  s_cbranch_scc1 Lexit
  v_lshrrev_b32 v10, 3, v1
  v_and_b32 v11, 7, v1
  v_lshrrev_b32 v12, 1, v11
  v_and_b32 v11, 1, v11
  v_lshlrev_b32 v11, 4, v11
  v_lshrrev_b32 v13, 1, v10
  v_and_b32 v13, 1, v13
  v_xor_b32 v12, v12, v13
  v_mul_u32_u24 v10, 896, v10
  s_lshl_b32 s70, s69, 7
  v_add3_u32 v10, v10, v11, s70
  v_lshlrev_b32 v13, 5, v12
  v_add_u32 v16, v10, v13
  v_xor_b32 v12, 2, v12
  v_lshlrev_b32 v13, 5, v12
  v_add_u32 v17, v10, v13
  v_lshlrev_b32 v24, 3, v1
  v_add_u32 v24, s63, v24
  v_add_u32 v24, 57344, v24
  v_mov_b32 v26, 0
  v_mov_b32 v27, 0
  ds_write_b64 v24, v[26:27]
  s_mov_b32 s73, 0
  s_mov_b32 s70, 0
  s_mov_b32 m0, s63
Lwo_50:
  s_add_u32 s71, s70, 7168
  buffer_load_dwordx4 v16, s[52:55], s70 offen lds
  s_add_u32 m0, m0, 1024
  s_add_u32 s72, s70, 14336
  buffer_load_dwordx4 v16, s[52:55], s71 offen lds
  s_add_u32 m0, m0, 1024
  s_add_u32 s71, s70, 21504
  buffer_load_dwordx4 v17, s[52:55], s72 offen lds
  s_add_u32 m0, m0, 1024
  s_add_u32 s70, s70, 25088
  s_mov_b32 exec_hi, 0
  buffer_load_dwordx4 v17, s[52:55], s71 offen lds
  s_mov_b32 exec_hi, -1
  s_add_u32 m0, m0, 512
  s_add_u32 s73, s73, 1
  s_cmp_lt_u32 s73, 16
  s_cbranch_scc1 Lwo_50
  s_waitcnt lgkmcnt(0)
  s_mul_i32 s4, s5, 0x9e3779b1
  s_add_u32 s4, s4, 0x85ebca6b
  v_and_b32 v10, 7, v1
  v_lshlrev_b32 v12, 4, v10
  s_lshr_b32 s71, s68, 1
  v_add_u32 v12, s71, v12
  v_lshlrev_b32 v12, 7, v12
  v_add_u32 v15, 69632, v12
  s_mov_b64 exec, 0xff
  s_mov_b32 s6, 0
Lpoll_51:
  buffer_load_dword v14, v15, s[48:51], 0 offen sc1
  s_add_u32 s6, s6, 1
  s_waitcnt vmcnt(0)
  v_cmp_ne_u32 vcc, s4, v14
  s_cmp_gt_u32 s6, 100000
  s_cbranch_scc1 Lpdone_52
  s_cbranch_vccz Lpdone_52
  s_mov_b64 exec, vcc
  s_sleep 16
  s_branch Lpoll_51
Lpdone_52:
  s_mov_b64 exec, -1
  s_waitcnt vmcnt(0) lgkmcnt(0)
  s_barrier
  s_barrier
  s_barrier
  s_barrier
  s_barrier
  s_endpgm
Lexit:
  s_endpgm
.p2align 6
Ltab_la:
  .long 0x0
  .long 0x3f800000
  .long 0x40000000
  .long 0x40400000
  .long 0x40800000
  .long 0x40a00000
  .long 0x40c00000
  .long 0x40e00000
  .long 0x44000000
  .long 0x44010000
  .long 0x44800000
  .long 0x44c00000
  .long 0x45000000
  .long 0x0
  .long 0x0
  .long 0x0
  .long 0x0
  .long 0x3f800000
  .long 0x40000000
  .long 0x40400000
  .long 0x40800000
  .long 0x40a00000
  .long 0x40c00000
  .long 0x40e00000
  .long 0x44000000
  .long 0x44010000
  .long 0x44800000
  .long 0x44c00000
  .long 0x45000000
  .long 0x0
  .long 0x0
  .long 0x0
  .long 0x0
  .long 0x3f800000
  .long 0x40000000
  .long 0x40400000
  .long 0x40800000
  .long 0x40a00000
  .long 0x40c00000
  .long 0x40e00000
  .long 0x44000000
  .long 0x44010000
  .long 0x44800000
  .long 0x44c00000
  .long 0x45000000
  .long 0x0
  .long 0x0
  .long 0x0
  .long 0x0
  .long 0x3f800000
  .long 0x40000000
  .long 0x40400000
  .long 0x40800000
  .long 0x40a00000
  .long 0x40c00000
  .long 0x40e00000
  .long 0x44000000
  .long 0x44010000
  .long 0x44800000
  .long 0x44c00000
  .long 0x45000000
  .long 0x0
  .long 0x0
  .long 0x0
Ltab_scat:
  .long 0x40000
  .long 0xc0008
  .long 0x2040200
  .long 0x20c0208
  .long 0xb000400
  .long 0xb000404
  .long 0xb000500
  .long 0xb000504
  .long 0x240020
  .long 0x2c0028
  .long 0x2240220
  .long 0x22c0228
  .long 0xb040410
  .long 0xb040414
  .long 0xb040510
  .long 0xb040514
  .long 0x440040
  .long 0x4c0048
  .long 0x2440240
  .long 0x24c0248
  .long 0xb080420
  .long 0xb080424
  .long 0xb080520
  .long 0xb080524
  .long 0x640060
  .long 0x6c0068
  .long 0x2640260
  .long 0x26c0268
  .long 0xb0c0430
  .long 0xb0c0434
  .long 0xb0c0530
  .long 0xb0c0534
  .long 0x840080
  .long 0x8c0088
  .long 0x2840280
  .long 0x28c0288
  .long 0xb100440
  .long 0xb100444
  .long 0xb100540
  .long 0xb100544
  .long 0xa400a0
  .long 0xac00a8
  .long 0x2a402a0
  .long 0x2ac02a8
  .long 0xb140450
  .long 0xb140454
  .long 0xb140550
  .long 0xb140554
  .long 0xc400c0
  .long 0xcc00c8
  .long 0x2c402c0
  .long 0x2cc02c8
  .long 0xb180460
  .long 0xb180464
  .long 0xb180560
  .long 0xb180564
  .long 0xe400e0
  .long 0xec00e8
  .long 0x2e402e0
  .long 0x2ec02e8
  .long 0xb1c0470
  .long 0xb1c0474
  .long 0xb1c0570
  .long 0xb1c0574
  .long 0x1040100
  .long 0x10c0108
  .long 0x3040300
  .long 0x30c0308
  .long 0xb200480
  .long 0xb200484
  .long 0xb200580
  .long 0xb200584
  .long 0x1240120
  .long 0x12c0128
  .long 0x3240320
  .long 0x32c0328
  .long 0xb240490
  .long 0xb240494
  .long 0xb240590
  .long 0xb240594
  .long 0x1440140
  .long 0x14c0148
  .long 0x3440340
  .long 0x34c0348
  .long 0xb2804a0
  .long 0xb2804a4
  .long 0xb2805a0
  .long 0xb2805a4
  .long 0x1640160
  .long 0x16c0168
  .long 0x3640360
  .long 0x36c0368
  .long 0xb2c04b0
  .long 0xb2c04b4
  .long 0xb2c05b0
  .long 0xb2c05b4
  .long 0x1840180
  .long 0x18c0188
  .long 0x3840380
  .long 0x38c0388
  .long 0xb3004c0
  .long 0xb3004c4
  .long 0xb3005c0
  .long 0xb3005c4
  .long 0x1a401a0
  .long 0x1ac01a8
  .long 0x3a403a0
  .long 0x3ac03a8
  .long 0xb3404d0
  .long 0xb3404d4
  .long 0xb3405d0
  .long 0xb3405d4
  .long 0x1c401c0
  .long 0x1cc01c8
  .long 0x3c403c0
  .long 0x3cc03c8
  .long 0xb3804e0
  .long 0xb3804e4
  .long 0xb3805e0
  .long 0xb3805e4
  .long 0x1e401e0
  .long 0x1ec01e8
  .long 0x3e403e0
  .long 0x3ec03e8
  .long 0xb3c04f0
  .long 0xb3c04f4
  .long 0xb3c05f0
  .long 0xb3c05f4
  .long 0x140010
  .long 0x1c0018
  .long 0x2140210
  .long 0x21c0218
  .long 0xb400408
  .long 0xb40040c
  .long 0xb400508
  .long 0xb40050c
  .long 0x340030
  .long 0x3c0038
  .long 0x2340230
  .long 0x23c0238
  .long 0xb440418
  .long 0xb44041c
  .long 0xb440518
  .long 0xb44051c
  .long 0x540050
  .long 0x5c0058
  .long 0x2540250
  .long 0x25c0258
  .long 0xb480428
  .long 0xb48042c
  .long 0xb480528
  .long 0xb48052c
  .long 0x740070
  .long 0x7c0078
  .long 0x2740270
  .long 0x27c0278
  .long 0xb4c0438
  .long 0xb4c043c
  .long 0xb4c0538
  .long 0xb4c053c
  .long 0x940090
  .long 0x9c0098
  .long 0x2940290
  .long 0x29c0298
  .long 0xb500448
  .long 0xb50044c
  .long 0xb500548
  .long 0xb50054c
  .long 0xb400b0
  .long 0xbc00b8
  .long 0x2b402b0
  .long 0x2bc02b8
  .long 0xb540458
  .long 0xb54045c
  .long 0xb540558
  .long 0xb54055c
  .long 0xd400d0
  .long 0xdc00d8
  .long 0x2d402d0
  .long 0x2dc02d8
  .long 0xb580468
  .long 0xb58046c
  .long 0xb580568
  .long 0xb58056c
  .long 0xf400f0
  .long 0xfc00f8
  .long 0x2f402f0
  .long 0x2fc02f8
  .long 0xb5c0478
  .long 0xb5c047c
  .long 0xb5c0578
  .long 0xb5c057c
  .long 0x1140110
  .long 0x11c0118
  .long 0x3140310
  .long 0x31c0318
  .long 0xb600488
  .long 0xb60048c
  .long 0xb600588
  .long 0xb60058c
  .long 0x1340130
  .long 0x13c0138
  .long 0x3340330
  .long 0x33c0338
  .long 0xb640498
  .long 0xb64049c
  .long 0xb640598
  .long 0xb64059c
  .long 0x1540150
  .long 0x15c0158
  .long 0x3540350
  .long 0x35c0358
  .long 0xb6804a8
  .long 0xb6804ac
  .long 0xb6805a8
  .long 0xb6805ac
  .long 0x1740170
  .long 0x17c0178
  .long 0x3740370
  .long 0x37c0378
  .long 0xb6c04b8
  .long 0xb6c04bc
  .long 0xb6c05b8
  .long 0xb6c05bc
  .long 0x1940190
  .long 0x19c0198
  .long 0x3940390
  .long 0x39c0398
  .long 0xb7004c8
  .long 0xb7004cc
  .long 0xb7005c8
  .long 0xb7005cc
  .long 0x1b401b0
  .long 0x1bc01b8
  .long 0x3b403b0
  .long 0x3bc03b8
  .long 0xb7404d8
  .long 0xb7404dc
  .long 0xb7405d8
  .long 0xb7405dc
  .long 0x1d401d0
  .long 0x1dc01d8
  .long 0x3d403d0
  .long 0x3dc03d8
  .long 0xb7804e8
  .long 0xb7804ec
  .long 0xb7805e8
  .long 0xb7805ec
  .long 0x1f401f0
  .long 0x1fc01f8
  .long 0x3f403f0
  .long 0x3fc03f8
  .long 0xb7c04f8
  .long 0xb7c04fc
  .long 0xb7c05f8
  .long 0xb7c05fc
  .long 0x6040600
  .long 0x9000800
  .long 0x6840680
  .long 0x9400840
  .long 0x7040700
  .long 0x9800880
  .long 0x7840780
  .long 0x9c008c0
  .long 0x60c0608
  .long 0x9040804
  .long 0x68c0688
  .long 0x9440844
  .long 0x70c0708
  .long 0x9840884
  .long 0x78c0788
  .long 0x9c408c4
  .long 0x6140610
  .long 0x9080808
  .long 0x6940690
  .long 0x9480848
  .long 0x7140710
  .long 0x9880888
  .long 0x7940790
  .long 0x9c808c8
  .long 0x61c0618
  .long 0x90c080c
  .long 0x69c0698
  .long 0x94c084c
  .long 0x71c0718
  .long 0x98c088c
  .long 0x79c0798
  .long 0x9cc08cc
  .long 0x6240620
  .long 0x9100810
  .long 0x6a406a0
  .long 0x9500850
  .long 0x7240720
  .long 0x9900890
  .long 0x7a407a0
  .long 0x9d008d0
  .long 0x62c0628
  .long 0x9140814
  .long 0x6ac06a8
  .long 0x9540854
  .long 0x72c0728
  .long 0x9940894
  .long 0x7ac07a8
  .long 0x9d408d4
  .long 0x6340630
  .long 0x9180818
  .long 0x6b406b0
  .long 0x9580858
  .long 0x7340730
  .long 0x9980898
  .long 0x7b407b0
  .long 0x9d808d8
  .long 0x63c0638
  .long 0x91c081c
  .long 0x6bc06b8
  .long 0x95c085c
  .long 0x73c0738
  .long 0x99c089c
  .long 0x7bc07b8
  .long 0x9dc08dc
  .long 0x6440640
  .long 0x9200820
  .long 0x6c406c0
  .long 0x9600860
  .long 0x7440740
  .long 0x9a008a0
  .long 0x7c407c0
  .long 0x9e008e0
  .long 0x64c0648
  .long 0x9240824
  .long 0x6cc06c8
  .long 0x9640864
  .long 0x74c0748
  .long 0x9a408a4
  .long 0x7cc07c8
  .long 0x9e408e4
  .long 0x6540650
  .long 0x9280828
  .long 0x6d406d0
  .long 0x9680868
  .long 0x7540750
  .long 0x9a808a8
  .long 0x7d407d0
  .long 0x9e808e8
  .long 0x65c0658
  .long 0x92c082c
  .long 0x6dc06d8
  .long 0x96c086c
  .long 0x75c0758
  .long 0x9ac08ac
  .long 0x7dc07d8
  .long 0x9ec08ec
  .long 0x6640660
  .long 0x9300830
  .long 0x6e406e0
  .long 0x9700870
  .long 0x7640760
  .long 0x9b008b0
  .long 0x7e407e0
  .long 0x9f008f0
  .long 0x66c0668
  .long 0x9340834
  .long 0x6ec06e8
  .long 0x9740874
  .long 0x76c0768
  .long 0x9b408b4
  .long 0x7ec07e8
  .long 0x9f408f4
  .long 0x6740670
  .long 0x9380838
  .long 0x6f406f0
  .long 0x9780878
  .long 0x7740770
  .long 0x9b808b8
  .long 0x7f407f0
  .long 0x9f808f8
  .long 0x67c0678
  .long 0x93c083c
  .long 0x6fc06f8
  .long 0x97c087c
  .long 0x77c0778
  .long 0x9bc08bc
  .long 0x7fc07f8
  .long 0x9fc08fc
  .long 0xbc00a00
  .long 0xbc00bc0
  .long 0xbc00bc0
  .long 0xbc00bc0
  .long 0xbc00bc0
  .long 0xbc00bc0
  .long 0xbc00bc0
  .long 0xbc00bc0
  .long 0xbc40bc4
  .long 0xbc40bc4
  .long 0xbc40bc4
  .long 0xbc40bc4
  .long 0xbc40bc4
  .long 0xbc40bc4
  .long 0xbc40bc4
  .long 0xbc40bc4
  .long 0xbc80bc8
  .long 0xbc80bc8
  .long 0xbc80bc8
  .long 0xbc80bc8
  .long 0xbc80bc8
  .long 0xbc80bc8
  .long 0xbc80bc8
  .long 0xbc80bc8
  .long 0xbcc0bcc
  .long 0xbcc0bcc
  .long 0xbcc0bcc
  .long 0xbcc0bcc
  .long 0xbcc0bcc
  .long 0xbcc0bcc
  .long 0xbcc0bcc
  .long 0xbcc0bcc
  .long 0xbd00bd0
  .long 0xbd00bd0
  .long 0xbd00bd0
  .long 0xbd00bd0
  .long 0xbd00bd0
  .long 0xbd00bd0
  .long 0xbd00bd0
  .long 0xbd00bd0
  .long 0xbd40bd4
  .long 0xbd40bd4
  .long 0xbd40bd4
  .long 0xbd40bd4
  .long 0xbd40bd4
  .long 0xbd40bd4
  .long 0xbd40bd4
  .long 0xbd40bd4
  .long 0xbd80bd8
  .long 0xbd80bd8
  .long 0xbd80bd8
  .long 0xbd80bd8
  .long 0xbd80bd8
  .long 0xbd80bd8
  .long 0xbd80bd8
  .long 0xbd80bd8
  .long 0xbdc0bdc
  .long 0xbdc0bdc
  .long 0xbdc0bdc
  .long 0xbdc0bdc
  .long 0xbdc0bdc
  .long 0xbdc0bdc
  .long 0xbdc0bdc
  .long 0xbdc0bdc
  .long 0xbe00be0
  .long 0xbe00be0
  .long 0xbe00be0
  .long 0xbe00be0
  .long 0xbe00be0
  .long 0xbe00be0
  .long 0xbe00be0
  .long 0xbe00be0
  .long 0xbe40be4
  .long 0xbe40be4
  .long 0xbe40be4
  .long 0xbe40be4
  .long 0xbe40be4
  .long 0xbe40be4
  .long 0xbe40be4
  .long 0xbe40be4
  .long 0xbe80be8
  .long 0xbe80be8
  .long 0xbe80be8
  .long 0xbe80be8
  .long 0xbe80be8
  .long 0xbe80be8
  .long 0xbe80be8
  .long 0xbe80be8
  .long 0xbec0bec
  .long 0xbec0bec
  .long 0xbec0bec
  .long 0xbec0bec
  .long 0xbec0bec
  .long 0xbec0bec
  .long 0xbec0bec
  .long 0xbec0bec
  .long 0xbf00bf0
  .long 0xbf00bf0
  .long 0xbf00bf0
  .long 0xbf00bf0
  .long 0xbf00bf0
  .long 0xbf00bf0
  .long 0xbf00bf0
  .long 0xbf00bf0
  .long 0xbf40bf4
  .long 0xbf40bf4
  .long 0xbf40bf4
  .long 0xbf40bf4
  .long 0xbf40bf4
  .long 0xbf40bf4
  .long 0xbf40bf4
  .long 0xbf40bf4
  .long 0xbf80bf8
  .long 0xbf80bf8
  .long 0xbf80bf8
  .long 0xbf80bf8
  .long 0xbf80bf8
  .long 0xbf80bf8
  .long 0xbf80bf8
  .long 0xbf80bf8
  .long 0xbfc0bfc
  .long 0xbfc0bfc
  .long 0xbfc0bfc
  .long 0xbfc0bfc
  .long 0xbfc0bfc
  .long 0xbfc0bfc
  .long 0xbfc0bfc
  .long 0xbfc0bfc
Ltab_exp:
  .long 0xa000a00
  .long 0x9c009c0
  .long 0x9800980
  .long 0x9400940
  .long 0x9000900
  .long 0x8c008c0
  .long 0x8800880
  .long 0x8400840
  .long 0xa000a00
  .long 0x9c009c0
  .long 0x9800980
  .long 0x9400940
  .long 0x9000900
  .long 0x8c008c0
  .long 0x8800880
  .long 0x8400840
  .long 0x9fc09fc
  .long 0x9bc09bc
  .long 0x97c097c
  .long 0x93c093c
  .long 0x8fc08fc
  .long 0x8bc08bc
  .long 0x87c087c
  .long 0x83c083c
  .long 0x9fc09fc
  .long 0x9bc09bc
  .long 0x97c097c
  .long 0x93c093c
  .long 0x8fc08fc
  .long 0x8bc08bc
  .long 0x87c087c
  .long 0x83c083c
  .long 0x9fc09fc
  .long 0x9bc09bc
  .long 0x97c097c
  .long 0x93c093c
  .long 0x8fc08fc
  .long 0x8bc08bc
  .long 0x87c087c
  .long 0x83c083c
  .long 0x9f809fc
  .long 0x9b809bc
  .long 0x978097c
  .long 0x938093c
  .long 0x8f808fc
  .long 0x8b808bc
  .long 0x878087c
  .long 0x838083c
  .long 0x9f809f8
  .long 0x9b809b8
  .long 0x9780978
  .long 0x9380938
  .long 0x8f808f8
  .long 0x8b808b8
  .long 0x8780878
  .long 0x8380838
  .long 0x9f809f8
  .long 0x9b809b8
  .long 0x9780978
  .long 0x9380938
  .long 0x8f808f8
  .long 0x8b808b8
  .long 0x8780878
  .long 0x8380838
  .long 0x9f809f8
  .long 0x9b809b8
  .long 0x9780978
  .long 0x9380938
  .long 0x8f808f8
  .long 0x8b808b8
  .long 0x8780878
  .long 0x8380838
  .long 0x9f809f8
  .long 0x9b809b8
  .long 0x9780978
  .long 0x9380938
  .long 0x8f808f8
  .long 0x8b808b8
  .long 0x8780878
  .long 0x8380838
  .long 0x9f409f4
  .long 0x9b409b4
  .long 0x9740974
  .long 0x9340934
  .long 0x8f408f4
  .long 0x8b408b4
  .long 0x8740874
  .long 0x8340834
  .long 0x9f409f4
  .long 0x9b409b4
  .long 0x9740974
  .long 0x9340934
  .long 0x8f408f4
  .long 0x8b408b4
  .long 0x8740874
  .long 0x8340834
  .long 0x9f409f4
  .long 0x9b409b4
  .long 0x9740974
  .long 0x9340934
  .long 0x8f408f4
  .long 0x8b408b4
  .long 0x8740874
  .long 0x8340834
  .long 0x9f009f4
  .long 0x9b009b4
  .long 0x9700974
  .long 0x9300934
  .long 0x8f008f4
  .long 0x8b008b4
  .long 0x8700874
  .long 0x8300834
  .long 0x9f009f0
  .long 0x9b009b0
  .long 0x9700970
  .long 0x9300930
  .long 0x8f008f0
  .long 0x8b008b0
  .long 0x8700870
  .long 0x8300830
  .long 0x9f009f0
  .long 0x9b009b0
  .long 0x9700970
  .long 0x9300930
  .long 0x8f008f0
  .long 0x8b008b0
  .long 0x8700870
  .long 0x8300830
  .long 0x9f009f0
  .long 0x9b009b0
  .long 0x9700970
  .long 0x9300930
  .long 0x8f008f0
  .long 0x8b008b0
  .long 0x8700870
  .long 0x8300830
  .long 0x9f009f0
  .long 0x9b009b0
  .long 0x9700970
  .long 0x9300930
  .long 0x8f008f0
  .long 0x8b008b0
  .long 0x8700870
  .long 0x8300830
  .long 0x9ec09ec
  .long 0x9ac09ac
  .long 0x96c096c
  .long 0x92c092c
  .long 0x8ec08ec
  .long 0x8ac08ac
  .long 0x86c086c
  .long 0x82c082c
  .long 0x9ec09ec
  .long 0x9ac09ac
  .long 0x96c096c
  .long 0x92c092c
  .long 0x8ec08ec
  .long 0x8ac08ac
  .long 0x86c086c
  .long 0x82c082c
  .long 0x9ec09ec
  .long 0x9ac09ac
  .long 0x96c096c
  .long 0x92c092c
  .long 0x8ec08ec
  .long 0x8ac08ac
  .long 0x86c086c
  .long 0x82c082c
  .long 0x9e809ec
  .long 0x9a809ac
  .long 0x968096c
  .long 0x928092c
  .long 0x8e808ec
  .long 0x8a808ac
  .long 0x868086c
  .long 0x828082c
  .long 0x9e809e8
  .long 0x9a809a8
  .long 0x9680968
  .long 0x9280928
  .long 0x8e808e8
  .long 0x8a808a8
  .long 0x8680868
  .long 0x8280828
  .long 0x9e809e8
  .long 0x9a809a8
  .long 0x9680968
  .long 0x9280928
  .long 0x8e808e8
  .long 0x8a808a8
  .long 0x8680868
  .long 0x8280828
  .long 0x9e809e8
  .long 0x9a809a8
  .long 0x9680968
  .long 0x9280928
  .long 0x8e808e8
  .long 0x8a808a8
  .long 0x8680868
  .long 0x8280828
  .long 0x9e809e8
  .long 0x9a809a8
  .long 0x9680968
  .long 0x9280928
  .long 0x8e808e8
  .long 0x8a808a8
  .long 0x8680868
  .long 0x8280828
  .long 0x9e409e4
  .long 0x9a409a4
  .long 0x9640964
  .long 0x9240924
  .long 0x8e408e4
  .long 0x8a408a4
  .long 0x8640864
  .long 0x8240824
  .long 0x9e409e4
  .long 0x9a409a4
  .long 0x9640964
  .long 0x9240924
  .long 0x8e408e4
  .long 0x8a408a4
  .long 0x8640864
  .long 0x8240824
  .long 0x9e409e4
  .long 0x9a409a4
  .long 0x9640964
  .long 0x9240924
  .long 0x8e408e4
  .long 0x8a408a4
  .long 0x8640864
  .long 0x8240824
  .long 0x9e009e4
  .long 0x9a009a4
  .long 0x9600964
  .long 0x9200924
  .long 0x8e008e4
  .long 0x8a008a4
  .long 0x8600864
  .long 0x8200824
  .long 0x9e009e0
  .long 0x9a009a0
  .long 0x9600960
  .long 0x9200920
  .long 0x8e008e0
  .long 0x8a008a0
  .long 0x8600860
  .long 0x8200820
  .long 0x9e009e0
  .long 0x9a009a0
  .long 0x9600960
  .long 0x9200920
  .long 0x8e008e0
  .long 0x8a008a0
  .long 0x8600860
  .long 0x8200820
  .long 0x9e009e0
  .long 0x9a009a0
  .long 0x9600960
  .long 0x9200920
  .long 0x8e008e0
  .long 0x8a008a0
  .long 0x8600860
  .long 0x8200820
  .long 0x9e009e0
  .long 0x9a009a0
  .long 0x9600960
  .long 0x9200920
  .long 0x8e008e0
  .long 0x8a008a0
  .long 0x8600860
  .long 0x8200820
  .long 0x9dc09dc
  .long 0x99c099c
  .long 0x95c095c
  .long 0x91c091c
  .long 0x8dc08dc
  .long 0x89c089c
  .long 0x85c085c
  .long 0x81c081c
  .long 0x9dc09dc
  .long 0x99c099c
  .long 0x95c095c
  .long 0x91c091c
  .long 0x8dc08dc
  .long 0x89c089c
  .long 0x85c085c
  .long 0x81c081c
  .long 0x9dc09dc
  .long 0x99c099c
  .long 0x95c095c
  .long 0x91c091c
  .long 0x8dc08dc
  .long 0x89c089c
  .long 0x85c085c
  .long 0x81c081c
  .long 0x9d809dc
  .long 0x998099c
  .long 0x958095c
  .long 0x918091c
  .long 0x8d808dc
  .long 0x898089c
  .long 0x858085c
  .long 0x818081c
  .long 0x9d809d8
  .long 0x9980998
  .long 0x9580958
  .long 0x9180918
  .long 0x8d808d8
  .long 0x8980898
  .long 0x8580858
  .long 0x8180818
  .long 0x9d809d8
  .long 0x9980998
  .long 0x9580958
  .long 0x9180918
  .long 0x8d808d8
  .long 0x8980898
  .long 0x8580858
  .long 0x8180818
  .long 0x9d809d8
  .long 0x9980998
  .long 0x9580958
  .long 0x9180918
  .long 0x8d808d8
  .long 0x8980898
  .long 0x8580858
  .long 0x8180818
  .long 0x9d809d8
  .long 0x9980998
  .long 0x9580958
  .long 0x9180918
  .long 0x8d808d8
  .long 0x8980898
  .long 0x8580858
  .long 0x8180818
  .long 0x9d409d4
  .long 0x9940994
  .long 0x9540954
  .long 0x9140914
  .long 0x8d408d4
  .long 0x8940894
  .long 0x8540854
  .long 0x8140814
  .long 0x9d409d4
  .long 0x9940994
  .long 0x9540954
  .long 0x9140914
  .long 0x8d408d4
  .long 0x8940894
  .long 0x8540854
  .long 0x8140814
  .long 0x9d409d4
  .long 0x9940994
  .long 0x9540954
  .long 0x9140914
  .long 0x8d408d4
  .long 0x8940894
  .long 0x8540854
  .long 0x8140814
  .long 0x9d009d4
  .long 0x9900994
  .long 0x9500954
  .long 0x9100914
  .long 0x8d008d4
  .long 0x8900894
  .long 0x8500854
  .long 0x8100814
  .long 0x9d009d0
  .long 0x9900990
  .long 0x9500950
  .long 0x9100910
  .long 0x8d008d0
  .long 0x8900890
  .long 0x8500850
  .long 0x8100810
  .long 0x9d009d0
  .long 0x9900990
  .long 0x9500950
  .long 0x9100910
  .long 0x8d008d0
  .long 0x8900890
  .long 0x8500850
  .long 0x8100810
  .long 0x9d009d0
  .long 0x9900990
  .long 0x9500950
  .long 0x9100910
  .long 0x8d008d0
  .long 0x8900890
  .long 0x8500850
  .long 0x8100810
  .long 0x9d009d0
  .long 0x9900990
  .long 0x9500950
  .long 0x9100910
  .long 0x8d008d0
  .long 0x8900890
  .long 0x8500850
  .long 0x8100810
  .long 0x9cc09cc
  .long 0x98c098c
  .long 0x94c094c
  .long 0x90c090c
  .long 0x8cc08cc
  .long 0x88c088c
  .long 0x84c084c
  .long 0x80c080c
  .long 0x9cc09cc
  .long 0x98c098c
  .long 0x94c094c
  .long 0x90c090c
  .long 0x8cc08cc
  .long 0x88c088c
  .long 0x84c084c
  .long 0x80c080c
  .long 0x9cc09cc
  .long 0x98c098c
  .long 0x94c094c
  .long 0x90c090c
  .long 0x8cc08cc
  .long 0x88c088c
  .long 0x84c084c
  .long 0x80c080c
  .long 0x9c809cc
  .long 0x988098c
  .long 0x948094c
  .long 0x908090c
  .long 0x8c808cc
  .long 0x888088c
  .long 0x848084c
  .long 0x808080c
  .long 0x9c809c8
  .long 0x9880988
  .long 0x9480948
  .long 0x9080908
  .long 0x8c808c8
  .long 0x8880888
  .long 0x8480848
  .long 0x8080808
  .long 0x9c809c8
  .long 0x9880988
  .long 0x9480948
  .long 0x9080908
  .long 0x8c808c8
  .long 0x8880888
  .long 0x8480848
  .long 0x8080808
  .long 0x9c809c8
  .long 0x9880988
  .long 0x9480948
  .long 0x9080908
  .long 0x8c808c8
  .long 0x8880888
  .long 0x8480848
  .long 0x8080808
  .long 0x9c809c8
  .long 0x9880988
  .long 0x9480948
  .long 0x9080908
  .long 0x8c808c8
  .long 0x8880888
  .long 0x8480848
  .long 0x8080808
  .long 0x9c409c4
  .long 0x9840984
  .long 0x9440944
  .long 0x9040904
  .long 0x8c408c4
  .long 0x8840884
  .long 0x8440844
  .long 0x8040804
  .long 0x9c409c4
  .long 0x9840984
  .long 0x9440944
  .long 0x9040904
  .long 0x8c408c4
  .long 0x8840884
  .long 0x8440844
  .long 0x8040804
  .long 0x9c409c4
  .long 0x9840984
  .long 0x9440944
  .long 0x9040904
  .long 0x8c408c4
  .long 0x8840884
  .long 0x8440844
  .long 0x8040804
  .long 0x9c009c4
  .long 0x9800984
  .long 0x9400944
  .long 0x9000904
  .long 0x8c008c4
  .long 0x8800884
  .long 0x8400844
  .long 0x8000804
  .long 0x9c009c0
  .long 0x9800980
  .long 0x9400940
  .long 0x9000900
  .long 0x8c008c0
  .long 0x8800880
  .long 0x8400840
  .long 0x8000800
  .long 0x9c009c0
  .long 0x9800980
  .long 0x9400940
  .long 0x9000900
  .long 0x8c008c0
  .long 0x8800880
  .long 0x8400840
  .long 0x8000800
  .long 0x8000800
  .long 0x7800780
  .long 0x7000700
  .long 0x6800680
  .long 0x5fc0600
  .long 0x4fc0500
  .long 0x3f803fc
  .long 0x1f801fc
  .long 0x7fc07fc
  .long 0x77c077c
  .long 0x6fc06fc
  .long 0x67c067c
  .long 0x5f805f8
  .long 0x4f804f8
  .long 0x3f003f4
  .long 0x1f001f4
  .long 0x7f807fc
  .long 0x778077c
  .long 0x6f806fc
  .long 0x678067c
  .long 0x5f405f8
  .long 0x4f404f8
  .long 0x3e803ec
  .long 0x1e801ec
  .long 0x7f807f8
  .long 0x7780778
  .long 0x6f806f8
  .long 0x6780678
  .long 0x5f005f0
  .long 0x4f004f0
  .long 0x3e003e4
  .long 0x1e001e4
  .long 0x7f807f8
  .long 0x7780778
  .long 0x6f806f8
  .long 0x6780678
  .long 0x5ec05f0
  .long 0x4ec04f0
  .long 0x3d803dc
  .long 0x1d801dc
  .long 0x7f407f4
  .long 0x7740774
  .long 0x6f406f4
  .long 0x6740674
  .long 0x5e805e8
  .long 0x4e804e8
  .long 0x3d003d4
  .long 0x1d001d4
  .long 0x7f007f4
  .long 0x7700774
  .long 0x6f006f4
  .long 0x6700674
  .long 0x5e405e8
  .long 0x4e404e8
  .long 0x3c803cc
  .long 0x1c801cc
  .long 0x7f007f0
  .long 0x7700770
  .long 0x6f006f0
  .long 0x6700670
  .long 0x5e005e0
  .long 0x4e004e0
  .long 0x3c003c4
  .long 0x1c001c4
  .long 0x7f007f0
  .long 0x7700770
  .long 0x6f006f0
  .long 0x6700670
  .long 0x5dc05e0
  .long 0x4dc04e0
  .long 0x3b803bc
  .long 0x1b801bc
  .long 0x7ec07ec
  .long 0x76c076c
  .long 0x6ec06ec
  .long 0x66c066c
  .long 0x5d805d8
  .long 0x4d804d8
  .long 0x3b003b4
  .long 0x1b001b4
  .long 0x7e807ec
  .long 0x768076c
  .long 0x6e806ec
  .long 0x668066c
  .long 0x5d405d8
  .long 0x4d404d8
  .long 0x3a803ac
  .long 0x1a801ac
  .long 0x7e807e8
  .long 0x7680768
  .long 0x6e806e8
  .long 0x6680668
  .long 0x5d005d0
  .long 0x4d004d0
  .long 0x3a003a4
  .long 0x1a001a4
  .long 0x7e807e8
  .long 0x7680768
  .long 0x6e806e8
  .long 0x6680668
  .long 0x5cc05d0
  .long 0x4cc04d0
  .long 0x398039c
  .long 0x198019c
  .long 0x7e407e4
  .long 0x7640764
  .long 0x6e406e4
  .long 0x6640664
  .long 0x5c805c8
  .long 0x4c804c8
  .long 0x3900394
  .long 0x1900194
  .long 0x7e007e4
  .long 0x7600764
  .long 0x6e006e4
  .long 0x6600664
  .long 0x5c405c8
  .long 0x4c404c8
  .long 0x388038c
  .long 0x188018c
  .long 0x7e007e0
  .long 0x7600760
  .long 0x6e006e0
  .long 0x6600660
  .long 0x5c005c0
  .long 0x4c004c0
  .long 0x3800384
  .long 0x1800184
  .long 0x7e007e0
  .long 0x7600760
  .long 0x6e006e0
  .long 0x6600660
  .long 0x5bc05c0
  .long 0x4bc04c0
  .long 0x378037c
  .long 0x178017c
  .long 0x7dc07dc
  .long 0x75c075c
  .long 0x6dc06dc
  .long 0x65c065c
  .long 0x5b805b8
  .long 0x4b804b8
  .long 0x3700374
  .long 0x1700174
  .long 0x7d807dc
  .long 0x758075c
  .long 0x6d806dc
  .long 0x658065c
  .long 0x5b405b8
  .long 0x4b404b8
  .long 0x368036c
  .long 0x168016c
  .long 0x7d807d8
  .long 0x7580758
  .long 0x6d806d8
  .long 0x6580658
  .long 0x5b005b0
  .long 0x4b004b0
  .long 0x3600364
  .long 0x1600164
  .long 0x7d807d8
  .long 0x7580758
  .long 0x6d806d8
  .long 0x6580658
  .long 0x5ac05b0
  .long 0x4ac04b0
  .long 0x358035c
  .long 0x158015c
  .long 0x7d407d4
  .long 0x7540754
  .long 0x6d406d4
  .long 0x6540654
  .long 0x5a805a8
  .long 0x4a804a8
  .long 0x3500354
  .long 0x1500154
  .long 0x7d007d4
  .long 0x7500754
  .long 0x6d006d4
  .long 0x6500654
  .long 0x5a405a8
  .long 0x4a404a8
  .long 0x348034c
  .long 0x148014c
  .long 0x7d007d0
  .long 0x7500750
  .long 0x6d006d0
  .long 0x6500650
  .long 0x5a005a0
  .long 0x4a004a0
  .long 0x3400344
  .long 0x1400144
  .long 0x7d007d0
  .long 0x7500750
  .long 0x6d006d0
  .long 0x6500650
  .long 0x59c05a0
  .long 0x49c04a0
  .long 0x338033c
  .long 0x138013c
  .long 0x7cc07cc
  .long 0x74c074c
  .long 0x6cc06cc
  .long 0x64c064c
  .long 0x5980598
  .long 0x4980498
  .long 0x3300334
  .long 0x1300134
  .long 0x7c807cc
  .long 0x748074c
  .long 0x6c806cc
  .long 0x648064c
  .long 0x5940598
  .long 0x4940498
  .long 0x328032c
  .long 0x128012c
  .long 0x7c807c8
  .long 0x7480748
  .long 0x6c806c8
  .long 0x6480648
  .long 0x5900590
  .long 0x4900490
  .long 0x3200324
  .long 0x1200124
  .long 0x7c807c8
  .long 0x7480748
  .long 0x6c806c8
  .long 0x6480648
  .long 0x58c0590
  .long 0x48c0490
  .long 0x318031c
  .long 0x118011c
  .long 0x7c407c4
  .long 0x7440744
  .long 0x6c406c4
  .long 0x6440644
  .long 0x5880588
  .long 0x4880488
  .long 0x3100314
  .long 0x1100114
  .long 0x7c007c4
  .long 0x7400744
  .long 0x6c006c4
  .long 0x6400644
  .long 0x5840588
  .long 0x4840488
  .long 0x308030c
  .long 0x108010c
  .long 0x7c007c0
  .long 0x7400740
  .long 0x6c006c0
  .long 0x6400640
  .long 0x5800580
  .long 0x4800480
  .long 0x3000304
  .long 0x1000104
  .long 0x7c007c0
  .long 0x7400740
  .long 0x6c006c0
  .long 0x6400640
  .long 0x57c0580
  .long 0x47c0480
  .long 0x2f802fc
  .long 0xf800fc
  .long 0x7bc07bc
  .long 0x73c073c
  .long 0x6bc06bc
  .long 0x63c063c
  .long 0x5780578
  .long 0x4780478
  .long 0x2f002f4
  .long 0xf000f4
  .long 0x7b807bc
  .long 0x738073c
  .long 0x6b806bc
  .long 0x638063c
  .long 0x5740578
  .long 0x4740478
  .long 0x2e802ec
  .long 0xe800ec
  .long 0x7b807b8
  .long 0x7380738
  .long 0x6b806b8
  .long 0x6380638
  .long 0x5700570
  .long 0x4700470
  .long 0x2e002e4
  .long 0xe000e4
  .long 0x7b807b8
  .long 0x7380738
  .long 0x6b806b8
  .long 0x6380638
  .long 0x56c0570
  .long 0x46c0470
  .long 0x2d802dc
  .long 0xd800dc
  .long 0x7b407b4
  .long 0x7340734
  .long 0x6b406b4
  .long 0x6340634
  .long 0x5680568
  .long 0x4680468
  .long 0x2d002d4
  .long 0xd000d4
  .long 0x7b007b4
  .long 0x7300734
  .long 0x6b006b4
  .long 0x6300634
  .long 0x5640568
  .long 0x4640468
  .long 0x2c802cc
  .long 0xc800cc
  .long 0x7b007b0
  .long 0x7300730
  .long 0x6b006b0
  .long 0x6300630
  .long 0x5600560
  .long 0x4600460
  .long 0x2c002c4
  .long 0xc000c4
  .long 0x7b007b0
  .long 0x7300730
  .long 0x6b006b0
  .long 0x6300630
  .long 0x55c0560
  .long 0x45c0460
  .long 0x2b802bc
  .long 0xb800bc
  .long 0x7ac07ac
  .long 0x72c072c
  .long 0x6ac06ac
  .long 0x62c062c
  .long 0x5580558
  .long 0x4580458
  .long 0x2b002b4
  .long 0xb000b4
  .long 0x7a807ac
  .long 0x728072c
  .long 0x6a806ac
  .long 0x628062c
  .long 0x5540558
  .long 0x4540458
  .long 0x2a802ac
  .long 0xa800ac
  .long 0x7a807a8
  .long 0x7280728
  .long 0x6a806a8
  .long 0x6280628
  .long 0x5500550
  .long 0x4500450
  .long 0x2a002a4
  .long 0xa000a4
  .long 0x7a807a8
  .long 0x7280728
  .long 0x6a806a8
  .long 0x6280628
  .long 0x54c0550
  .long 0x44c0450
  .long 0x298029c
  .long 0x98009c
  .long 0x7a407a4
  .long 0x7240724
  .long 0x6a406a4
  .long 0x6240624
  .long 0x5480548
  .long 0x4480448
  .long 0x2900294
  .long 0x900094
  .long 0x7a007a4
  .long 0x7200724
  .long 0x6a006a4
  .long 0x6200624
  .long 0x5440548
  .long 0x4440448
  .long 0x288028c
  .long 0x88008c
  .long 0x7a007a0
  .long 0x7200720
  .long 0x6a006a0
  .long 0x6200620
  .long 0x5400540
  .long 0x4400440
  .long 0x2800284
  .long 0x800084
  .long 0x7a007a0
  .long 0x7200720
  .long 0x6a006a0
  .long 0x6200620
  .long 0x53c0540
  .long 0x43c0440
  .long 0x278027c
  .long 0x78007c
  .long 0x79c079c
  .long 0x71c071c
  .long 0x69c069c
  .long 0x61c061c
  .long 0x5380538
  .long 0x4380438
  .long 0x2700274
  .long 0x700074
  .long 0x798079c
  .long 0x718071c
  .long 0x698069c
  .long 0x618061c
  .long 0x5340538
  .long 0x4340438
  .long 0x268026c
  .long 0x68006c
  .long 0x7980798
  .long 0x7180718
  .long 0x6980698
  .long 0x6180618
  .long 0x5300530
  .long 0x4300430
  .long 0x2600264
  .long 0x600064
  .long 0x7980798
  .long 0x7180718
  .long 0x6980698
  .long 0x6180618
  .long 0x52c0530
  .long 0x42c0430
  .long 0x258025c
  .long 0x58005c
  .long 0x7940794
  .long 0x7140714
  .long 0x6940694
  .long 0x6140614
  .long 0x5280528
  .long 0x4280428
  .long 0x2500254
  .long 0x500054
  .long 0x7900794
  .long 0x7100714
  .long 0x6900694
  .long 0x6100614
  .long 0x5240528
  .long 0x4240428
  .long 0x248024c
  .long 0x48004c
  .long 0x7900790
  .long 0x7100710
  .long 0x6900690
  .long 0x6100610
  .long 0x5200520
  .long 0x4200420
  .long 0x2400244
  .long 0x400044
  .long 0x7900790
  .long 0x7100710
  .long 0x6900690
  .long 0x6100610
  .long 0x51c0520
  .long 0x41c0420
  .long 0x238023c
  .long 0x38003c
  .long 0x78c078c
  .long 0x70c070c
  .long 0x68c068c
  .long 0x60c060c
  .long 0x5180518
  .long 0x4180418
  .long 0x2300234
  .long 0x300034
  .long 0x788078c
  .long 0x708070c
  .long 0x688068c
  .long 0x608060c
  .long 0x5140518
  .long 0x4140418
  .long 0x228022c
  .long 0x28002c
  .long 0x7880788
  .long 0x7080708
  .long 0x6880688
  .long 0x6080608
  .long 0x5100510
  .long 0x4100410
  .long 0x2200224
  .long 0x200024
  .long 0x7880788
  .long 0x7080708
  .long 0x6880688
  .long 0x6080608
  .long 0x50c0510
  .long 0x40c0410
  .long 0x218021c
  .long 0x18001c
  .long 0x7840784
  .long 0x7040704
  .long 0x6840684
  .long 0x6040604
  .long 0x5080508
  .long 0x4080408
  .long 0x2100214
  .long 0x100014
  .long 0x7800784
  .long 0x7000704
  .long 0x6800684
  .long 0x6000604
  .long 0x5040508
  .long 0x4040408
  .long 0x208020c
  .long 0x8000c
  .long 0x7800780
  .long 0x7000700
  .long 0x6800680
  .long 0x6000600
  .long 0x5000500
  .long 0x4000400
  .long 0x2000204
  .long 0x4
  .fill 288, 4, 0xbf800000
Lcode_end:

.section .rodata,"a"
.p2align 6
.amdhsa_kernel concat_heads__ssm_conv_s4__linear_kernel_hedgehog__prompt_kernel
  .amdhsa_next_free_vgpr 128
  .amdhsa_next_free_sgpr 102
  .amdhsa_accum_offset 128
  .amdhsa_group_segment_fixed_size 0
  .amdhsa_kernarg_size 128
  .amdhsa_user_sgpr_count 2
  .amdhsa_user_sgpr_kernarg_segment_ptr 1
  .amdhsa_system_sgpr_workgroup_id_x 1
.end_amdhsa_kernel
```
